```python
import torch

def _softmax(x, axis=-1):
    return torch.softmax(x, dim=axis)
def _gelu(x):
    return torch.nn.functional.gelu(x, approximate="tanh")
def _silu(x):
    return torch.nn.functional.silu(x)
def _sigmoid(x):
    return torch.sigmoid(x)
def _layernorm(x, axis=-1, eps=1e-5):
    m = x.mean(dim=axis, keepdim=True)
    v = x.var(dim=axis, keepdim=True, unbiased=False)
    return (x - m) / torch.sqrt(v + eps)
def _scatter_add(tgt, idx, src, axis=0):
    return tgt.clone().index_add_(axis, idx, src)
def _segment_sum(src, seg, n):
    out = torch.zeros((n,) + src.shape[1:], dtype=src.dtype)
    return out.index_add_(0, seg, src)
def _pad(x, pw):
    flat = tuple(v for pair in reversed(pw) for v in pair)
    return torch.nn.functional.pad(x, flat)

kernel_name = 'standalone__cross_network_dcn_v2__recsys'

def setup_inputs():

    _w = (lambda a: (lambda t: t.to(torch.bfloat16) if t.is_floating_point() else t)(torch.as_tensor(a)))
    B, F, D, L = 4096, 100, 16, 6
    Din = min(F * D, 512)
    R = max(Din // 4, 2)
    sc = Din ** -0.5
    return {
        "x0": _w((lambda *s: torch.randn(*s, dtype=torch.bfloat16) * 0.05)(B, Din)),
        "U":  _w((lambda *s: torch.randn(*s, dtype=torch.bfloat16) * 1.6)(L, Din, R) * sc),
        "V":  _w((lambda *s: torch.randn(*s, dtype=torch.bfloat16) * 1.6)(L, R, Din) * sc),
        "bs": _w((lambda *s: torch.randn(*s, dtype=torch.bfloat16) * 0.05)(L, Din)),
    }

def reference(x0, U, V, bs):
    x = x0
    for l in range(U.shape[0]):
        h = torch.einsum('rd,bd->br', V[l], x)
        h = torch.einsum('dr,br->bd', U[l], h)
        x = x0 * (h + bs[l]) + x
    return x
```

```asm
; @launch grid=(256,1,1) block=(256,1,1) lds=156224
.amdgcn_target "amdgcn-amd-amdhsa--gfx950"
.text
.globl standalone__cross_network_dcn_v2__recsys_kernel
.p2align 8
.type standalone__cross_network_dcn_v2__recsys_kernel,@function
standalone__cross_network_dcn_v2__recsys_kernel:
  s_cmp_ge_u32 s2, 256
  s_cbranch_scc1 L_end
  s_getpc_b64 s[46:47]
  v_mul_u32_u24 v13, 40, v0
  global_load_dword v13, v13, s[46:47]
  s_load_dwordx2 s[4:5], s[0:1], 0
  s_load_dwordx2 s[12:13], s[0:1], 16
  s_load_dwordx2 s[20:21], s[0:1], 32
  s_load_dwordx2 s[28:29], s[0:1], 40
  s_load_dwordx2 s[16:17], s[0:1], 24
  s_load_dwordx2 s[8:9], s[0:1], 8
  s_load_dwordx2 s[24:25], s[0:1], 48
  v_and_b32 v1, 63, v0
  v_lshrrev_b32 v2, 6, v0
  s_getreg_b32 s55, hwreg(HW_REG_XCC_ID, 0, 4)
  v_readfirstlane_b32 s52, v2
  s_lshr_b32 s53, s2, 3
  s_and_b32 s53, s53, 3
  s_lshr_b32 s72, s2, 5
  s_lshl_b32 s72, s72, 3
  s_and_b32 s54, s2, 7
  s_add_u32 s54, s54, s72
  s_lshl_b32 s76, s54, 16
  s_lshl_b32 s72, s53, 8
  s_add_u32 s76, s76, s72
  v_and_b32 v20, 15, v1
  v_lshrrev_b32 v21, 4, v1
  v_and_b32 v22, 1, v21
  v_lshlrev_b32 v22, 2, v22
  v_lshrrev_b32 v23, 1, v21
  v_lshl_add_u32 v22, v23, 4, v22
  v_lshlrev_b32 v2, 4, v20
  v_lshl_add_u32 v6, v22, 10, v2
  v_lshl_add_u32 v7, v22, 8, v2
  v_lshl_add_u32 v8, v21, 12, v2
  s_mov_b32 s22, 4194304
  s_mov_b32 s23, 0x00020000
  s_mov_b32 s14, 786432
  s_mov_b32 s15, 0x00020000
  s_mov_b32 s6, 4194304
  s_mov_b32 s7, 0x00020000
  s_mov_b32 s30, 256
  s_mov_b32 s31, 0x00020000
  s_mov_b32 s18, 6144
  s_mov_b32 s19, 0x00020000
  v_mov_b32 v72, 0
  v_mov_b32 v73, 0
  v_mov_b32 v74, 0
  v_mov_b32 v75, 0
  s_lshl_b32 s73, s52, 14
  s_add_u32 s56, s76, s73
  s_mul_i32 s64, s52, 8448
  s_bfe_u32 s51, s2, 0x10005
  s_lshl_b32 s73, s52, 15
  s_add_u32 s68, s72, s73
  s_mul_i32 s74, s52, 4224
  s_add_u32 s79, s74, 135168
  v_lshl_add_u32 v22, v21, 10, v2
  v_add_u32 v22, s72, v22
  v_add_u32 v23, 4096, v22
  s_lshl_b32 s73, s54, 2
  v_mov_b32 v14, s73
  s_or_b32 s55, s55, 0x10
  v_mov_b32 v15, s55
  s_mul_i32 s74, s2, 3072
  v_lshrrev_b32 v12, 1, v1
  v_min_u32 v12, 23, v12
  v_lshlrev_b32 v12, 7, v12
  s_mov_b32 s10, 786432
  s_mov_b32 s11, 0x00020000
  s_cmp_eq_u32 s52, 0
  s_waitcnt lgkmcnt(0)
  s_cbranch_scc0 L_x2
  buffer_load_dwordx4 v[120:123], v22, s[16:19], 0 offen
  buffer_load_dwordx4 v[124:127], v23, s[16:19], 0 offen
  s_branch L_xd
L_x2:
  s_cmp_eq_u32 s52, 3
  s_cbranch_scc0 L_x1
  s_mov_b64 exec, 1
  buffer_store_byte v15, v14, s[28:31], s53 offen
  s_mov_b64 exec, -1
  s_branch L_xd
L_x1:
  s_cmp_eq_u32 s52, 1
  s_cbranch_scc0 L_x6
  buffer_load_dword v13, v12, s[12:15], s74 offen
  s_branch L_xd
L_x6:
  buffer_load_dword v13, v12, s[8:11], s74 offen
L_xd:
  s_xor_b32 s74, s51, 0
  s_lshl_b32 s74, s74, 2
  s_and_b32 s73, s74, 4
  s_add_u32 s73, s73, s74
  s_lshl_b32 s65, s73, 10
  s_add_u32 s65, s65, s68
  s_mul_i32 s63, s74, 1056
  s_add_u32 s63, s63, s64
  s_xor_b32 s74, s51, 1
  s_lshl_b32 s74, s74, 2
  s_and_b32 s73, s74, 4
  s_add_u32 s73, s73, s74
  s_lshl_b32 s66, s73, 10
  s_add_u32 s66, s66, s68
  s_mul_i32 s48, s74, 1056
  s_add_u32 s48, s48, s64
  s_add_u32 m0, s63, 0
  s_nop 0
  buffer_load_dwordx4 v6, s[12:15], s65 offen offset:0  lds
  s_add_u32 m0, s63, 32
  s_nop 0
  buffer_load_dwordx4 v6, s[12:15], s65 offen offset:1024  lds
  s_add_u32 m0, s63, 64
  s_nop 0
  buffer_load_dwordx4 v6, s[12:15], s65 offen offset:2048  lds
  s_add_u32 m0, s63, 96
  s_nop 0
  buffer_load_dwordx4 v6, s[12:15], s65 offen offset:3072  lds
  s_add_u32 m0, s48, 0
  s_nop 0
  buffer_load_dwordx4 v6, s[12:15], s66 offen offset:0  lds
  s_add_u32 m0, s48, 32
  s_nop 0
  buffer_load_dwordx4 v6, s[12:15], s66 offen offset:1024  lds
  s_add_u32 m0, s48, 64
  s_nop 0
  buffer_load_dwordx4 v6, s[12:15], s66 offen offset:2048  lds
  s_add_u32 m0, s48, 96
  s_nop 0
  buffer_load_dwordx4 v6, s[12:15], s66 offen offset:3072  lds
  s_add_u32 m0, s79, 0
  s_nop 0
  buffer_load_dwordx4 v8, s[4:7], s56 offen offset:0 nt lds
  s_add_u32 m0, s79, 32
  s_nop 0
  buffer_load_dwordx4 v8, s[4:7], s56 offen offset:1024 nt lds
  s_add_u32 m0, s79, 64
  s_nop 0
  buffer_load_dwordx4 v8, s[4:7], s56 offen offset:2048 nt lds
  s_add_u32 m0, s79, 96
  s_nop 0
  buffer_load_dwordx4 v8, s[4:7], s56 offen offset:3072 nt lds
  buffer_store_dwordx4 v[72:75], v8, s[20:23], s56 offen offset:0
  buffer_store_dwordx4 v[72:75], v8, s[20:23], s56 offen offset:1024
  buffer_store_dwordx4 v[72:75], v8, s[20:23], s56 offen offset:2048
  buffer_store_dwordx4 v[72:75], v8, s[20:23], s56 offen offset:3072
  s_mov_b32 s26, 4194304
  s_mov_b32 s27, 0x00020000
  s_mov_b32 s34, 4194304
  s_mov_b32 s35, 0x00020000
  s_mul_i32 s75, s55, 0x01010101
  s_xor_b32 s57, s56, 256
  s_xor_b32 s58, s56, 512
  s_xor_b32 s59, s56, 768
  s_lshl_b32 s69, s53, 15
  s_lshl_b32 s73, s52, 13
  s_add_u32 s69, s69, s73
  s_mov_b32 s60, 0
  s_mov_b32 s61, 1
  s_mov_b32 s71, 0
  s_mov_b32 s3, 0
  s_mov_b64 s[32:33], s[20:21]
  s_add_u32 s62, s63, 67584
  s_xor_b32 s62, s62, s63
  s_add_u32 s49, s48, 67584
  s_xor_b32 s49, s49, s48
  v_and_b32 v9, 7, v1
  v_mul_u32_u24 v9, 1056, v9
  v_bfe_u32 v10, v1, 3, 1
  v_lshl_add_u32 v9, v10, 9, v9
  v_lshl_add_u32 v9, v21, 4, v9
  v_mov_b32 v4, v9
  v_add_u32 v9, 67584, v9
  v_xor_b32 v9, v4, v9
  v_lshlrev_b32 v5, 5, v21
  v_add_u32 v5, 152064, v5
  v_and_b32 v18, 3, v1
  v_mul_u32_u24 v18, 1056, v18
  v_bfe_u32 v10, v1, 2, 2
  v_lshl_add_u32 v18, v10, 8, v18
  v_lshl_add_u32 v18, v21, 4, v18
  v_add_u32 v18, s79, v18
  v_lshlrev_b32 v19, 4, v1
  v_add_u32 v19, s79, v19
  v_and_b32 v11, 1, v1
  v_lshlrev_b32 v11, 4, v11
  v_mov_b32 v17, 0x3f80
  v_lshlrev_b32 v17, v11, v17
  v_cmp_eq_u32 vcc, v10, v21
  v_bfe_u32 v11, v1, 1, 1
  s_nop 0
  v_cndmask_b32 v17, 0, v17, vcc
  v_cmp_eq_u32 vcc, 0, v11
  s_nop 1
  v_cndmask_b32 v16, 0, v17, vcc
  v_sub_u32 v17, v17, v16
  s_cmp_eq_u32 s52, 3
  s_cbranch_scc0 L_x3
  s_mov_b64 exec, 1
  buffer_load_dword v13, v14, s[28:31], 0 offen sc1
  s_mov_b64 exec, -1
  s_waitcnt vmcnt(9)
  s_branch L_b2
L_x3:
  s_cmp_eq_u32 s52, 0
  s_cbranch_scc0 L_x4
  v_lshlrev_b32 v2, 5, v20
  v_lshl_add_u32 v2, v21, 9, v2
  v_add_u32 v2, 152064, v2
  s_waitcnt vmcnt(16)
  v_lshlrev_b32 v128, 16, v120
  v_and_b32 v129, 0xffff0000, v120
  v_lshlrev_b32 v130, 16, v121
  v_and_b32 v131, 0xffff0000, v121
  v_lshlrev_b32 v132, 16, v122
  v_and_b32 v133, 0xffff0000, v122
  v_lshlrev_b32 v134, 16, v123
  v_and_b32 v135, 0xffff0000, v123
  ds_write_b128 v2, v[128:131] offset:0
  ds_write_b128 v2, v[132:135] offset:16
  v_lshlrev_b32 v136, 16, v124
  v_and_b32 v137, 0xffff0000, v124
  v_lshlrev_b32 v138, 16, v125
  v_and_b32 v139, 0xffff0000, v125
  v_lshlrev_b32 v140, 16, v126
  v_and_b32 v141, 0xffff0000, v126
  v_lshlrev_b32 v142, 16, v127
  v_and_b32 v143, 0xffff0000, v127
  ds_write_b128 v2, v[136:139] offset:2048
  ds_write_b128 v2, v[140:143] offset:2064
L_x4:
  s_waitcnt vmcnt(8)
L_b2:
  s_barrier
  buffer_store_dwordx4 v[72:75], v8, s[24:27], s56 offen offset:0
  ds_read_b128 a[0:3], v4 offset:0
  ds_read_b128 a[16:19], v4 offset:256
  ds_read_b128 a[4:7], v4 offset:64
  s_sub_u32 s73, s65, s68
  s_lshr_b32 s73, s73, 2
  buffer_store_dwordx4 v[72:75], v8, s[24:27], s56 offen offset:1024
  ds_read_b128 a[20:23], v4 offset:320
  ds_read_b128 a[8:11], v4 offset:128
  ds_read_b128 a[24:27], v4 offset:384
  s_add_u32 s67, s73, s69
  s_add_u32 s65, s65, 131072
  buffer_store_dwordx4 v[72:75], v8, s[24:27], s56 offen offset:2048
  ds_read_b128 a[12:15], v4 offset:192
  ds_read_b128 a[28:31], v4 offset:448
  ds_read_b128 a[32:35], v4 offset:8448
  s_xor_b32 s63, s63, s62
  s_sub_u32 s73, s66, s68
  buffer_store_dwordx4 v[72:75], v8, s[24:27], s56 offen offset:3072
  ds_read_b128 a[48:51], v4 offset:8704
  ds_read_b128 a[36:39], v4 offset:8512
  ds_read_b128 a[52:55], v4 offset:8768
  s_lshr_b32 s73, s73, 2
  s_add_u32 s50, s73, s69
  s_add_u32 s66, s66, 131072
  s_xor_b32 s48, s48, s49
  s_cmp_eq_u32 s52, 3
  s_cbranch_scc0 L_np0
  s_mov_b64 exec, 1
  buffer_load_dword v3, v14, s[28:31], 0 offen sc1
  s_mov_b64 exec, -1
L_np0:
  s_add_u32 m0, s63, 33792
  ds_read_b128 a[40:43], v4 offset:8576
  ds_read_b128 a[56:59], v4 offset:8832
  buffer_load_dwordx4 v7, s[8:11], s67 offen offset:0  lds
  s_add_u32 m0, s63, 34592
  ds_read_b128 a[44:47], v4 offset:8640
  ds_read_b128 a[60:63], v4 offset:8896
  buffer_load_dwordx4 v7, s[8:11], s67 offen offset:256  lds
  s_add_u32 m0, s63, 35392
  ds_read_b128 a[64:67], v4 offset:16896
  ds_read_b128 a[80:83], v4 offset:17152
  buffer_load_dwordx4 v7, s[8:11], s67 offen offset:512  lds
  s_add_u32 m0, s63, 36192
  ds_read_b128 a[68:71], v4 offset:16960
  ds_read_b128 a[84:87], v4 offset:17216
  buffer_load_dwordx4 v7, s[8:11], s67 offen offset:768  lds
  s_add_u32 m0, s48, 33792
  ds_read_b128 a[72:75], v4 offset:17024
  ds_read_b128 a[88:91], v4 offset:17280
  buffer_load_dwordx4 v7, s[8:11], s50 offen offset:0  lds
  s_add_u32 m0, s48, 34592
  ds_read_b128 a[76:79], v4 offset:17088
  ds_read_b128 a[92:95], v4 offset:17344
  buffer_load_dwordx4 v7, s[8:11], s50 offen offset:256  lds
  s_add_u32 m0, s48, 35392
  ds_read_b128 a[96:99], v4 offset:25344
  ds_read_b128 a[112:115], v4 offset:25600
  buffer_load_dwordx4 v7, s[8:11], s50 offen offset:512  lds
  s_add_u32 m0, s48, 36192
  ds_read_b128 a[100:103], v4 offset:25408
  ds_read_b128 a[116:119], v4 offset:25664
  buffer_load_dwordx4 v7, s[8:11], s50 offen offset:768  lds
  ds_read_b128 a[104:107], v4 offset:25472
  ds_read_b128 a[120:123], v4 offset:25728
  ds_read_b128 a[108:111], v4 offset:25536
  ds_read_b128 a[124:127], v4 offset:25792
  s_cmp_eq_u32 s52, 3
  s_cbranch_scc1 L_w3p
  s_waitcnt vmcnt(8)
  s_branch L_pb1
L_w3p:
  s_waitcnt vmcnt(9)
  v_readfirstlane_b32 s72, v13
  s_mov_b32 s70, 0
  s_mov_b64 exec, 1
  s_and_b32 s72, s72, 0x1f1f1f1f
  s_cmp_eq_u32 s72, s75
  s_cbranch_scc1 L_polleda
  s_mov_b64 exec, 1
  s_waitcnt vmcnt(8)
  s_branch L_pchka
L_polla:
  buffer_load_dword v3, v14, s[28:31], 0 offen sc1
  s_add_u32 s71, s71, 1
  s_waitcnt vmcnt(0)
L_pchka:
  v_readfirstlane_b32 s72, v3
  s_mov_b32 s70, 1
  s_cmp_gt_u32 s71, 64
  s_cbranch_scc1 L_polleda
  s_and_b32 s72, s72, 0x1f1f1f1f
  s_cmp_eq_u32 s72, s75
  s_cbranch_scc0 L_polla
  s_mov_b32 s70, 0
L_polleda:
  v_mov_b32 v15, s70
  v_mov_b32 v2, 156160
  ds_write_b32 v2, v15
  s_or_b32 s72, s55, 0x40
  v_mov_b32 v15, s72
  s_mov_b64 exec, -1
  s_mov_b32 s71, 0
L_pb1:
  s_waitcnt lgkmcnt(0)
  s_barrier
  v_mov_b32 v2, 156160
  ds_read_b32 v2, v2
  ds_read_b128 v[24:27], v18 offset:0
  ds_read_b128 v[28:31], v18 offset:64
  ds_read_b128 v[32:35], v18 offset:128
  ds_read_b128 v[36:39], v18 offset:192
  s_cmp_eq_u32 s52, 3
  s_cbranch_scc0 L_np1
  s_mov_b64 exec, 1
  buffer_store_byte v15, v14, s[28:31], s53 offen
  s_mov_b64 exec, -1
L_np1:
  s_waitcnt lgkmcnt(4)
  v_readfirstlane_b32 s70, v2
  s_nop 0
  s_cmp_lg_u32 s70, 0
  s_cbranch_scc1 L_slowinit
  s_waitcnt lgkmcnt(3)
  v_mfma_f32_16x16x32_bf16 v[120:123], a[0:3], v[24:27], 0
  s_add_u32 m0, s63, 0
  v_mfma_f32_16x16x32_bf16 v[124:127], a[16:19], v[24:27], 0
  buffer_load_dwordx4 v6, s[12:15], s65 offen offset:0  lds
  s_waitcnt lgkmcnt(2)
  v_mfma_f32_16x16x32_bf16 v[120:123], a[4:7], v[28:31], v[120:123]
  s_add_u32 m0, s63, 32
  v_mfma_f32_16x16x32_bf16 v[124:127], a[20:23], v[28:31], v[124:127]
  buffer_load_dwordx4 v6, s[12:15], s65 offen offset:1024  lds
  s_waitcnt lgkmcnt(1)
  v_mfma_f32_16x16x32_bf16 v[120:123], a[8:11], v[32:35], v[120:123]
  s_add_u32 m0, s63, 64
  v_mfma_f32_16x16x32_bf16 v[124:127], a[24:27], v[32:35], v[124:127]
  buffer_load_dwordx4 v6, s[12:15], s65 offen offset:2048  lds
  s_waitcnt lgkmcnt(0)
  v_mfma_f32_16x16x32_bf16 v[120:123], a[12:15], v[36:39], v[120:123]
  s_add_u32 m0, s63, 96
  v_mfma_f32_16x16x32_bf16 v[124:127], a[28:31], v[36:39], v[124:127]
  ds_read_b128 v[152:155], v5 offset:0
  buffer_load_dwordx4 v6, s[12:15], s65 offen offset:3072  lds
  v_mfma_f32_16x16x32_bf16 v[128:131], a[32:35], v[24:27], 0
  ds_read_b128 v[156:159], v5 offset:16
  s_add_u32 m0, s48, 0
  v_mfma_f32_16x16x32_bf16 v[132:135], a[48:51], v[24:27], 0
  ds_read_b128 v[160:163], v5 offset:128
  buffer_load_dwordx4 v6, s[12:15], s66 offen offset:0  lds
  v_mfma_f32_16x16x32_bf16 v[128:131], a[36:39], v[28:31], v[128:131]
  v_cvt_pk_bf16_f32 v40, v120, v121
  v_cvt_pk_bf16_f32 v41, v122, v123
  v_mfma_f32_16x16x32_bf16 v[132:135], a[52:55], v[28:31], v[132:135]
  v_bfi_b32 v40, 1, s61, v40
  v_cvt_pk_bf16_f32 v42, v124, v125
  v_mfma_f32_16x16x32_bf16 v[128:131], a[40:43], v[32:35], v[128:131]
  v_cvt_pk_bf16_f32 v43, v126, v127
  buffer_store_dwordx4 v[40:43], v8, s[32:35], s56 offen offset:0
  v_mfma_f32_16x16x32_bf16 v[132:135], a[56:59], v[32:35], v[132:135]
  ds_read_b128 v[164:167], v5 offset:144
  s_add_u32 m0, s48, 32
  v_mfma_f32_16x16x32_bf16 v[128:131], a[44:47], v[36:39], v[128:131]
  ds_read_b128 v[168:171], v5 offset:256
  buffer_load_dwordx4 v6, s[12:15], s66 offen offset:1024  lds
  v_mfma_f32_16x16x32_bf16 v[132:135], a[60:63], v[36:39], v[132:135]
  ds_read_b128 v[172:175], v5 offset:272
  s_add_u32 m0, s48, 64
  v_mfma_f32_16x16x32_bf16 v[136:139], a[64:67], v[24:27], 0
  ds_read_b128 v[176:179], v5 offset:384
  buffer_load_dwordx4 v6, s[12:15], s66 offen offset:2048  lds
  v_mfma_f32_16x16x32_bf16 v[140:143], a[80:83], v[24:27], 0
  ds_read_b128 v[180:183], v5 offset:400
  s_add_u32 m0, s48, 96
  v_mfma_f32_16x16x32_bf16 v[136:139], a[68:71], v[28:31], v[136:139]
  v_cvt_pk_bf16_f32 v44, v128, v129
  v_cvt_pk_bf16_f32 v45, v130, v131
  v_mfma_f32_16x16x32_bf16 v[140:143], a[84:87], v[28:31], v[140:143]
  v_bfi_b32 v44, 1, s61, v44
  v_cvt_pk_bf16_f32 v46, v132, v133
  v_mfma_f32_16x16x32_bf16 v[136:139], a[72:75], v[32:35], v[136:139]
  v_cvt_pk_bf16_f32 v47, v134, v135
  buffer_store_dwordx4 v[44:47], v8, s[32:35], s56 offen offset:1024
  v_mfma_f32_16x16x32_bf16 v[140:143], a[88:91], v[32:35], v[140:143]
  buffer_load_dwordx4 v6, s[12:15], s66 offen offset:3072  lds
  v_mfma_f32_16x16x32_bf16 v[136:139], a[76:79], v[36:39], v[136:139]
  v_mfma_f32_16x16x32_bf16 v[140:143], a[92:95], v[36:39], v[140:143]
  s_nop 0
  s_nop 0
  v_mfma_f32_16x16x32_bf16 v[144:147], a[96:99], v[24:27], 0
  s_nop 0
  s_nop 0
  v_mfma_f32_16x16x32_bf16 v[148:151], a[112:115], v[24:27], 0
  s_nop 0
  s_nop 0
  v_mfma_f32_16x16x32_bf16 v[144:147], a[100:103], v[28:31], v[144:147]
  v_cvt_pk_bf16_f32 v48, v136, v137
  v_cvt_pk_bf16_f32 v49, v138, v139
  v_mfma_f32_16x16x32_bf16 v[148:151], a[116:119], v[28:31], v[148:151]
  v_bfi_b32 v48, 1, s61, v48
  v_cvt_pk_bf16_f32 v50, v140, v141
  v_mfma_f32_16x16x32_bf16 v[144:147], a[104:107], v[32:35], v[144:147]
  v_cvt_pk_bf16_f32 v51, v142, v143
  buffer_store_dwordx4 v[48:51], v8, s[32:35], s56 offen offset:2048
  v_mfma_f32_16x16x32_bf16 v[148:151], a[120:123], v[32:35], v[148:151]
  v_mfma_f32_16x16x32_bf16 v[144:147], a[108:111], v[36:39], v[144:147]
  v_mfma_f32_16x16x32_bf16 v[148:151], a[124:127], v[36:39], v[148:151]
  s_cmp_eq_u32 s52, 3
  s_cbranch_scc0 L_np2
  s_mov_b64 exec, 1
  buffer_load_dword v3, v14, s[28:31], 0 offen sc1
  s_mov_b64 exec, -1
L_np2:
  s_add_u32 s65, s65, 131072
  s_add_u32 s66, s66, 131072
  s_add_u32 s67, s67, 131072
  s_add_u32 s50, s50, 131072
  s_xor_b32 s63, s63, s62
  s_xor_b32 s48, s48, s49
  v_add_u32 v5, 512, v5
  v_xor_b32 v4, v9, v4
  v_cvt_pk_bf16_f32 v52, v144, v145
  v_cvt_pk_bf16_f32 v53, v146, v147
  v_bfi_b32 v52, 1, s61, v52
  v_cvt_pk_bf16_f32 v54, v148, v149
  v_cvt_pk_bf16_f32 v55, v150, v151
  buffer_store_dwordx4 v[52:55], v8, s[32:35], s56 offen offset:3072
  v_lshlrev_b32 v216, 16, v24
  v_and_b32 v217, 0xffff0000, v24
  v_lshlrev_b32 v218, 16, v25
  v_and_b32 v219, 0xffff0000, v25
  v_lshlrev_b32 v220, 16, v26
  v_and_b32 v221, 0xffff0000, v26
  v_lshlrev_b32 v222, 16, v27
  v_and_b32 v223, 0xffff0000, v27
  v_lshlrev_b32 v224, 16, v28
  v_and_b32 v225, 0xffff0000, v28
  v_lshlrev_b32 v226, 16, v29
  v_and_b32 v227, 0xffff0000, v29
  v_lshlrev_b32 v228, 16, v30
  v_and_b32 v229, 0xffff0000, v30
  v_lshlrev_b32 v230, 16, v31
  v_and_b32 v231, 0xffff0000, v31
  v_lshlrev_b32 v232, 16, v32
  v_and_b32 v233, 0xffff0000, v32
  v_lshlrev_b32 v234, 16, v33
  v_and_b32 v235, 0xffff0000, v33
  v_lshlrev_b32 v236, 16, v34
  v_and_b32 v237, 0xffff0000, v34
  v_lshlrev_b32 v238, 16, v35
  v_and_b32 v239, 0xffff0000, v35
  v_lshlrev_b32 v240, 16, v36
  v_and_b32 v241, 0xffff0000, v36
  v_lshlrev_b32 v242, 16, v37
  v_and_b32 v243, 0xffff0000, v37
  v_lshlrev_b32 v244, 16, v38
  v_and_b32 v245, 0xffff0000, v38
  v_lshlrev_b32 v246, 16, v39
  v_and_b32 v247, 0xffff0000, v39
  v_lshlrev_b32 v184, 16, v24
  v_and_b32 v185, 0xffff0000, v24
  v_lshlrev_b32 v186, 16, v25
  v_and_b32 v187, 0xffff0000, v25
  v_lshlrev_b32 v188, 16, v26
  v_and_b32 v189, 0xffff0000, v26
  v_lshlrev_b32 v190, 16, v27
  v_and_b32 v191, 0xffff0000, v27
  v_lshlrev_b32 v192, 16, v28
  v_and_b32 v193, 0xffff0000, v28
  v_lshlrev_b32 v194, 16, v29
  v_and_b32 v195, 0xffff0000, v29
  s_waitcnt vmcnt(2)
  s_cmp_eq_u32 s52, 3
  s_cbranch_scc0 L_b0
  s_mov_b64 exec, 1
  s_waitcnt vmcnt(1)
  s_branch L_pchkb
L_pollb:
  buffer_load_dword v3, v14, s[28:31], 0 offen sc1
  s_add_u32 s71, s71, 1
  s_waitcnt vmcnt(0)
L_pchkb:
  v_readfirstlane_b32 s72, v3
  s_cmp_gt_u32 s71, 0x40000
  s_cbranch_scc1 L_polledb
  s_and_b32 s72, s72, 0x40404040
  s_cmp_eq_u32 s72, 0x40404040
  s_cbranch_scc0 L_pollb
L_polledb:
  s_mov_b64 exec, -1
  s_mov_b32 s71, 0
L_b0:
  s_barrier
  s_branch L_B2f
L_topf:
  s_waitcnt lgkmcnt(15)
  v_mfma_f32_16x16x32_bf16 v[120:123], a[0:3], v[24:27], 0
  v_fma_f32 v192, v224, v160, v192
  v_fma_f32 v193, v225, v161, v193
  v_fma_f32 v194, v226, v162, v194
  v_fma_f32 v195, v227, v163, v195
  v_mfma_f32_16x16x32_bf16 v[124:127], a[16:19], v[24:27], 0
  v_cvt_pk_bf16_f32 v28, v192, v193
  v_fma_f32 v196, v228, v164, v196
  v_fma_f32 v197, v229, v165, v197
  v_cvt_pk_bf16_f32 v29, v194, v195
  v_fma_f32 v198, v230, v166, v198
  v_fma_f32 v199, v231, v167, v199
  v_cvt_pk_bf16_f32 v30, v196, v197
  v_cvt_pk_bf16_f32 v31, v198, v199
  v_fma_f32 v200, v232, v168, v200
  v_fma_f32 v201, v233, v169, v201
  v_mfma_f32_16x16x32_bf16 v[120:123], a[4:7], v[28:31], v[120:123]
  v_fma_f32 v202, v234, v170, v202
  v_fma_f32 v203, v235, v171, v203
  v_cvt_pk_bf16_f32 v32, v200, v201
  v_fma_f32 v204, v236, v172, v204
  v_mfma_f32_16x16x32_bf16 v[124:127], a[20:23], v[28:31], v[124:127]
  v_fma_f32 v205, v237, v173, v205
  v_cvt_pk_bf16_f32 v33, v202, v203
  v_fma_f32 v206, v238, v174, v206
  v_fma_f32 v207, v239, v175, v207
  v_cvt_pk_bf16_f32 v34, v204, v205
  v_cvt_pk_bf16_f32 v35, v206, v207
  v_fma_f32 v208, v240, v176, v208
  v_fma_f32 v209, v241, v177, v209
  v_mfma_f32_16x16x32_bf16 v[120:123], a[8:11], v[32:35], v[120:123]
  v_fma_f32 v210, v242, v178, v210
  v_fma_f32 v211, v243, v179, v211
  v_cvt_pk_bf16_f32 v36, v208, v209
  v_fma_f32 v212, v244, v180, v212
  v_mfma_f32_16x16x32_bf16 v[124:127], a[24:27], v[32:35], v[124:127]
  v_fma_f32 v213, v245, v181, v213
  v_cvt_pk_bf16_f32 v37, v210, v211
  v_fma_f32 v214, v246, v182, v214
  v_fma_f32 v215, v247, v183, v215
  v_cvt_pk_bf16_f32 v38, v212, v213
  v_cvt_pk_bf16_f32 v39, v214, v215
  v_mfma_f32_16x16x32_bf16 v[128:131], a[32:35], v[24:27], 0
  ds_read_b128 v[152:155], v5 offset:0
  s_add_u32 m0, s48, 32
  v_mfma_f32_16x16x32_bf16 v[132:135], a[48:51], v[24:27], 0
  ds_read_b128 v[156:159], v5 offset:16
  buffer_load_dwordx4 v6, s[12:15], s66 offen offset:1024  lds
  v_mfma_f32_16x16x32_bf16 v[120:123], a[12:15], v[36:39], v[120:123]
  ds_read_b128 v[160:163], v5 offset:128
  s_add_u32 m0, s48, 64
  v_mfma_f32_16x16x32_bf16 v[124:127], a[28:31], v[36:39], v[124:127]
  ds_read_b128 v[164:167], v5 offset:144
  buffer_load_dwordx4 v6, s[12:15], s66 offen offset:2048  lds
  s_add_u32 m0, s48, 96
  v_mfma_f32_16x16x32_bf16 v[128:131], a[36:39], v[28:31], v[128:131]
  ds_read_b128 v[168:171], v5 offset:256
  buffer_load_dwordx4 v6, s[12:15], s66 offen offset:3072  lds
  v_mfma_f32_16x16x32_bf16 v[132:135], a[52:55], v[28:31], v[132:135]
  ds_read_b128 v[172:175], v5 offset:272
  v_cvt_pk_bf16_f32 v40, v120, v121
  v_cvt_pk_bf16_f32 v41, v122, v123
  v_mfma_f32_16x16x32_bf16 v[128:131], a[40:43], v[32:35], v[128:131]
  v_bfi_b32 v40, 1, s61, v40
  v_cvt_pk_bf16_f32 v42, v124, v125
  v_cvt_pk_bf16_f32 v43, v126, v127
  buffer_store_dwordx4 v[40:43], v8, s[32:35], s56 offen offset:0
  v_mfma_f32_16x16x32_bf16 v[132:135], a[56:59], v[32:35], v[132:135]
  ds_read_b128 v[176:179], v5 offset:384
  s_add_u32 s65, s65, 131072
  v_mfma_f32_16x16x32_bf16 v[128:131], a[44:47], v[36:39], v[128:131]
  ds_read_b128 v[180:183], v5 offset:400
  s_add_u32 s66, s66, 131072
  v_mfma_f32_16x16x32_bf16 v[132:135], a[60:63], v[36:39], v[132:135]
  s_add_u32 s67, s67, 131072
  s_waitcnt lgkmcnt(8)
  v_mfma_f32_16x16x32_bf16 v[136:139], a[64:67], v[24:27], 0
  s_add_u32 s50, s50, 131072
  s_xor_b32 s63, s63, s62
  v_mfma_f32_16x16x32_bf16 v[140:143], a[80:83], v[24:27], 0
  s_xor_b32 s48, s48, s49
  v_add_u32 v5, 512, v5
  v_mfma_f32_16x16x32_bf16 v[136:139], a[68:71], v[28:31], v[136:139]
  v_cvt_pk_bf16_f32 v44, v128, v129
  v_cvt_pk_bf16_f32 v45, v130, v131
  v_mfma_f32_16x16x32_bf16 v[140:143], a[84:87], v[28:31], v[140:143]
  v_bfi_b32 v44, 1, s61, v44
  v_cvt_pk_bf16_f32 v46, v132, v133
  v_mfma_f32_16x16x32_bf16 v[136:139], a[72:75], v[32:35], v[136:139]
  v_cvt_pk_bf16_f32 v47, v134, v135
  buffer_store_dwordx4 v[44:47], v8, s[32:35], s56 offen offset:1024
  v_mfma_f32_16x16x32_bf16 v[140:143], a[88:91], v[32:35], v[140:143]
  v_xor_b32 v4, v9, v4
  v_lshlrev_b32 v184, 16, v24
  v_mfma_f32_16x16x32_bf16 v[136:139], a[76:79], v[36:39], v[136:139]
  v_and_b32 v185, 0xffff0000, v24
  v_lshlrev_b32 v186, 16, v25
  v_mfma_f32_16x16x32_bf16 v[140:143], a[92:95], v[36:39], v[140:143]
  v_and_b32 v187, 0xffff0000, v25
  s_nop 0
  v_mfma_f32_16x16x32_bf16 v[144:147], a[96:99], v[24:27], 0
  s_nop 0
  s_nop 0
  v_mfma_f32_16x16x32_bf16 v[148:151], a[112:115], v[24:27], 0
  s_nop 0
  s_nop 0
  v_mfma_f32_16x16x32_bf16 v[144:147], a[100:103], v[28:31], v[144:147]
  v_cvt_pk_bf16_f32 v48, v136, v137
  v_cvt_pk_bf16_f32 v49, v138, v139
  v_mfma_f32_16x16x32_bf16 v[148:151], a[116:119], v[28:31], v[148:151]
  v_bfi_b32 v48, 1, s61, v48
  v_cvt_pk_bf16_f32 v50, v140, v141
  v_mfma_f32_16x16x32_bf16 v[144:147], a[104:107], v[32:35], v[144:147]
  v_cvt_pk_bf16_f32 v51, v142, v143
  buffer_store_dwordx4 v[48:51], v8, s[32:35], s56 offen offset:2048
  v_mfma_f32_16x16x32_bf16 v[148:151], a[120:123], v[32:35], v[148:151]
  v_mfma_f32_16x16x32_bf16 v[144:147], a[108:111], v[36:39], v[144:147]
  v_mfma_f32_16x16x32_bf16 v[148:151], a[124:127], v[36:39], v[148:151]
  v_lshlrev_b32 v188, 16, v26
  v_and_b32 v189, 0xffff0000, v26
  v_lshlrev_b32 v190, 16, v27
  v_and_b32 v191, 0xffff0000, v27
  v_lshlrev_b32 v192, 16, v28
  v_and_b32 v193, 0xffff0000, v28
  v_lshlrev_b32 v194, 16, v29
  v_and_b32 v195, 0xffff0000, v29
  v_cvt_pk_bf16_f32 v52, v144, v145
  v_cvt_pk_bf16_f32 v53, v146, v147
  v_bfi_b32 v52, 1, s61, v52
  v_cvt_pk_bf16_f32 v54, v148, v149
  v_cvt_pk_bf16_f32 v55, v150, v151
  buffer_store_dwordx4 v[52:55], v8, s[32:35], s56 offen offset:3072
L_Bf:
  s_waitcnt vmcnt(4)
  s_barrier
  s_cmp_eq_u32 s60, 5
  s_cbranch_scc1 L_B2l
L_B2f:
  buffer_load_dwordx4 v[72:75], v8, s[32:35], s57 offen offset:0 sc1
  buffer_load_dwordx4 v[76:79], v8, s[32:35], s58 offen offset:0 sc1
  buffer_load_dwordx4 v[80:83], v8, s[32:35], s59 offen offset:0 sc1
  ds_read_b128 a[128:131], v4 offset:33792
  v_lshlrev_b32 v196, 16, v30
  ds_read_b128 a[144:147], v4 offset:34048
  v_and_b32 v197, 0xffff0000, v30
  ds_read_b128 a[160:163], v4 offset:42240
  v_lshlrev_b32 v198, 16, v31
  ds_read_b128 a[176:179], v4 offset:42496
  v_and_b32 v199, 0xffff0000, v31
  ds_read_b128 a[192:195], v4 offset:50688
  v_lshlrev_b32 v200, 16, v32
  buffer_load_dwordx4 v[84:87], v8, s[32:35], s57 offen offset:1024 sc1
  buffer_load_dwordx4 v[88:91], v8, s[32:35], s58 offen offset:1024 sc1
  buffer_load_dwordx4 v[92:95], v8, s[32:35], s59 offen offset:1024 sc1
  ds_read_b128 a[208:211], v4 offset:50944
  v_and_b32 v201, 0xffff0000, v32
  ds_read_b128 a[224:227], v4 offset:59136
  v_lshlrev_b32 v202, 16, v33
  ds_read_b128 a[240:243], v4 offset:59392
  v_and_b32 v203, 0xffff0000, v33
  ds_read_b128 a[132:135], v4 offset:33856
  v_lshlrev_b32 v204, 16, v34
  ds_read_b128 a[148:151], v4 offset:34112
  v_and_b32 v205, 0xffff0000, v34
  ds_read_b128 a[164:167], v4 offset:42304
  v_lshlrev_b32 v206, 16, v35
  ds_read_b128 a[180:183], v4 offset:42560
  v_and_b32 v207, 0xffff0000, v35
  buffer_load_dwordx4 v[96:99], v8, s[32:35], s57 offen offset:2048 sc1
  buffer_load_dwordx4 v[100:103], v8, s[32:35], s58 offen offset:2048 sc1
  buffer_load_dwordx4 v[104:107], v8, s[32:35], s59 offen offset:2048 sc1
  ds_read_b128 a[196:199], v4 offset:50752
  v_lshlrev_b32 v208, 16, v36
  ds_read_b128 a[212:215], v4 offset:51008
  v_and_b32 v209, 0xffff0000, v36
  ds_read_b128 a[228:231], v4 offset:59200
  v_lshlrev_b32 v210, 16, v37
  ds_read_b128 a[244:247], v4 offset:59456
  v_and_b32 v211, 0xffff0000, v37
  ds_read_b128 a[136:139], v4 offset:33920
  v_lshlrev_b32 v212, 16, v38
  ds_read_b128 a[152:155], v4 offset:34176
  v_and_b32 v213, 0xffff0000, v38
  ds_read_b128 a[168:171], v4 offset:42368
  v_lshlrev_b32 v214, 16, v39
  buffer_load_dwordx4 v[108:111], v8, s[32:35], s57 offen offset:3072 sc1
  buffer_load_dwordx4 v[112:115], v8, s[32:35], s58 offen offset:3072 sc1
  buffer_load_dwordx4 v[116:119], v8, s[32:35], s59 offen offset:3072 sc1
  ds_read_b128 a[184:187], v4 offset:42624
  v_and_b32 v215, 0xffff0000, v39
L_Cf:
  s_waitcnt vmcnt(9)
  v_mfma_f32_16x16x16_bf16 v[56:59], v[16:17], v[72:73], v[120:123]
  v_bitop3_b32 v10, v72, v76, s61 bitop3:0x7e
  v_bitop3_b32 v10, v10, v80, s61 bitop3:0xf6
  v_mfma_f32_16x16x16_bf16 v[60:63], v[16:17], v[74:75], v[124:127]
  v_and_b32 v10, 1, v10
  v_cmp_ne_u32 vcc, 0, v10
  v_mfma_f32_16x16x16_bf16 v[56:59], v[16:17], v[76:77], v[56:59]
  ds_read_b128 a[200:203], v4 offset:50816
  v_mfma_f32_16x16x16_bf16 v[60:63], v[16:17], v[78:79], v[60:63]
  ds_read_b128 a[216:219], v4 offset:51072
  v_mfma_f32_16x16x16_bf16 v[56:59], v[16:17], v[80:81], v[56:59]
  ds_read_b128 a[232:235], v4 offset:59264
  v_mfma_f32_16x16x16_bf16 v[60:63], v[16:17], v[82:83], v[60:63]
  s_cbranch_vccnz L_rt0f
L_go0f:
  s_waitcnt vmcnt(6)
  v_mfma_f32_16x16x16_bf16 v[64:67], v[16:17], v[84:85], v[128:131]
  v_bitop3_b32 v10, v84, v88, s61 bitop3:0x7e
  v_bitop3_b32 v10, v10, v92, s61 bitop3:0xf6
  v_mfma_f32_16x16x16_bf16 v[68:71], v[16:17], v[86:87], v[132:135]
  v_and_b32 v10, 1, v10
  v_cmp_ne_u32 vcc, 0, v10
  v_mfma_f32_16x16x16_bf16 v[64:67], v[16:17], v[88:89], v[64:67]
  v_cvt_pk_bf16_f32 v40, v56, v57
  v_cvt_pk_bf16_f32 v41, v58, v59
  v_mfma_f32_16x16x16_bf16 v[68:71], v[16:17], v[90:91], v[68:71]
  v_cvt_pk_bf16_f32 v42, v60, v61
  v_cvt_pk_bf16_f32 v43, v62, v63
  v_mfma_f32_16x16x16_bf16 v[64:67], v[16:17], v[92:93], v[64:67]
  ds_read_b128 a[248:251], v4 offset:59520
  s_add_u32 m0, s63, 33792
  v_mfma_f32_16x16x16_bf16 v[68:71], v[16:17], v[94:95], v[68:71]
  ds_read_b128 a[140:143], v4 offset:33984
  s_cbranch_vccnz L_rt1f
L_go1f:
  s_waitcnt lgkmcnt(15)
  v_mfma_f32_16x16x32_bf16 v[152:155], a[128:131], v[40:43], v[152:155]
  ds_read_b128 a[156:159], v4 offset:34240
  buffer_load_dwordx4 v7, s[8:11], s67 offen offset:0  lds
  v_mfma_f32_16x16x32_bf16 v[156:159], a[144:147], v[40:43], v[156:159]
  ds_read_b128 a[172:175], v4 offset:42432
  s_add_u32 m0, s63, 34592
  v_mfma_f32_16x16x32_bf16 v[160:163], a[160:163], v[40:43], v[160:163]
  ds_read_b128 a[188:191], v4 offset:42688
  buffer_load_dwordx4 v7, s[8:11], s67 offen offset:256  lds
  v_mfma_f32_16x16x32_bf16 v[164:167], a[176:179], v[40:43], v[164:167]
  ds_read_b128 a[204:207], v4 offset:50880
  v_cvt_pk_bf16_f32 v44, v64, v65
  v_cvt_pk_bf16_f32 v45, v66, v67
  v_mfma_f32_16x16x32_bf16 v[168:171], a[192:195], v[40:43], v[168:171]
  ds_read_b128 a[220:223], v4 offset:51136
  v_cvt_pk_bf16_f32 v46, v68, v69
  v_cvt_pk_bf16_f32 v47, v70, v71
  v_mfma_f32_16x16x32_bf16 v[172:175], a[208:211], v[40:43], v[172:175]
  ds_read_b128 a[236:239], v4 offset:59328
  s_add_u32 m0, s63, 35392
  v_mfma_f32_16x16x32_bf16 v[176:179], a[224:227], v[40:43], v[176:179]
  ds_read_b128 a[252:255], v4 offset:59584
  buffer_load_dwordx4 v7, s[8:11], s67 offen offset:512  lds
  v_mfma_f32_16x16x32_bf16 v[180:183], a[240:243], v[40:43], v[180:183]
  ds_read_b128 a[0:3], v4 offset:0
  s_add_u32 m0, s63, 36192
  s_waitcnt vmcnt(6)
  v_mfma_f32_16x16x16_bf16 v[56:59], v[16:17], v[96:97], v[136:139]
  ds_read_b128 a[16:19], v4 offset:256
  v_bitop3_b32 v10, v96, v100, s61 bitop3:0x7e
  v_bitop3_b32 v10, v10, v104, s61 bitop3:0xf6
  v_mfma_f32_16x16x16_bf16 v[60:63], v[16:17], v[98:99], v[140:143]
  ds_read_b128 a[4:7], v4 offset:64
  v_and_b32 v10, 1, v10
  v_cmp_ne_u32 vcc, 0, v10
  v_mfma_f32_16x16x16_bf16 v[56:59], v[16:17], v[100:101], v[56:59]
  ds_read_b128 a[20:23], v4 offset:320
  buffer_load_dwordx4 v7, s[8:11], s67 offen offset:768  lds
  v_mfma_f32_16x16x16_bf16 v[60:63], v[16:17], v[102:103], v[60:63]
  ds_read_b128 a[8:11], v4 offset:128
  s_add_u32 m0, s48, 33792
  v_mfma_f32_16x16x16_bf16 v[56:59], v[16:17], v[104:105], v[56:59]
  ds_read_b128 a[24:27], v4 offset:384
  buffer_load_dwordx4 v7, s[8:11], s50 offen offset:0  lds
  v_mfma_f32_16x16x16_bf16 v[60:63], v[16:17], v[106:107], v[60:63]
  ds_read_b128 a[12:15], v4 offset:192
  s_cbranch_vccnz L_rt2f
L_go2f:
  s_waitcnt lgkmcnt(15)
  v_mfma_f32_16x16x32_bf16 v[152:155], a[132:135], v[44:47], v[152:155]
  ds_read_b128 a[28:31], v4 offset:448
  s_add_u32 m0, s48, 34592
  v_mfma_f32_16x16x32_bf16 v[156:159], a[148:151], v[44:47], v[156:159]
  ds_read_b128 a[32:35], v4 offset:8448
  buffer_load_dwordx4 v7, s[8:11], s50 offen offset:256  lds
  v_mfma_f32_16x16x32_bf16 v[160:163], a[164:167], v[44:47], v[160:163]
  ds_read_b128 a[48:51], v4 offset:8704
  s_add_u32 m0, s48, 35392
  v_mfma_f32_16x16x32_bf16 v[164:167], a[180:183], v[44:47], v[164:167]
  ds_read_b128 a[36:39], v4 offset:8512
  v_cvt_pk_bf16_f32 v48, v56, v57
  v_cvt_pk_bf16_f32 v49, v58, v59
  v_mfma_f32_16x16x32_bf16 v[168:171], a[196:199], v[44:47], v[168:171]
  ds_read_b128 a[52:55], v4 offset:8768
  v_cvt_pk_bf16_f32 v50, v60, v61
  v_cvt_pk_bf16_f32 v51, v62, v63
  v_mfma_f32_16x16x32_bf16 v[172:175], a[212:215], v[44:47], v[172:175]
  ds_read_b128 a[40:43], v4 offset:8576
  buffer_load_dwordx4 v7, s[8:11], s50 offen offset:512  lds
  s_add_u32 m0, s48, 36192
  v_mfma_f32_16x16x32_bf16 v[176:179], a[228:231], v[44:47], v[176:179]
  ds_read_b128 a[56:59], v4 offset:8832
  buffer_load_dwordx4 v7, s[8:11], s50 offen offset:768  lds
  v_mfma_f32_16x16x32_bf16 v[180:183], a[244:247], v[44:47], v[180:183]
  ds_read_b128 a[44:47], v4 offset:8640
  s_waitcnt lgkmcnt(15)
  v_mfma_f32_16x16x32_bf16 v[152:155], a[136:139], v[48:51], v[152:155]
  ds_read_b128 a[60:63], v4 offset:8896
  s_add_u32 m0, s63, 0
  v_mfma_f32_16x16x32_bf16 v[156:159], a[152:155], v[48:51], v[156:159]
  ds_read_b128 a[64:67], v4 offset:16896
  buffer_load_dwordx4 v6, s[12:15], s65 offen offset:0  lds
  v_mfma_f32_16x16x32_bf16 v[160:163], a[168:171], v[48:51], v[160:163]
  ds_read_b128 a[80:83], v4 offset:17152
  v_mfma_f32_16x16x32_bf16 v[164:167], a[184:187], v[48:51], v[164:167]
  ds_read_b128 a[68:71], v4 offset:16960
  s_waitcnt vmcnt(9)
  v_mfma_f32_16x16x16_bf16 v[64:67], v[16:17], v[108:109], v[144:147]
  ds_read_b128 a[84:87], v4 offset:17216
  v_bitop3_b32 v10, v108, v112, s61 bitop3:0x7e
  v_bitop3_b32 v10, v10, v116, s61 bitop3:0xf6
  v_mfma_f32_16x16x16_bf16 v[68:71], v[16:17], v[110:111], v[148:151]
  ds_read_b128 a[72:75], v4 offset:17024
  v_and_b32 v10, 1, v10
  v_cmp_ne_u32 vcc, 0, v10
  v_mfma_f32_16x16x16_bf16 v[64:67], v[16:17], v[112:113], v[64:67]
  ds_read_b128 a[88:91], v4 offset:17280
  s_add_u32 m0, s63, 32
  v_mfma_f32_16x16x16_bf16 v[68:71], v[16:17], v[114:115], v[68:71]
  ds_read_b128 a[76:79], v4 offset:17088
  buffer_load_dwordx4 v6, s[12:15], s65 offen offset:1024  lds
  v_mfma_f32_16x16x16_bf16 v[64:67], v[16:17], v[116:117], v[64:67]
  ds_read_b128 a[92:95], v4 offset:17344
  s_add_u32 m0, s63, 64
  v_mfma_f32_16x16x16_bf16 v[68:71], v[16:17], v[118:119], v[68:71]
  ds_read_b128 a[96:99], v4 offset:25344
  s_cbranch_vccnz L_rt3f
L_go3f:
  v_mfma_f32_16x16x32_bf16 v[168:171], a[200:203], v[48:51], v[168:171]
  ds_read_b128 a[112:115], v4 offset:25600
  s_add_u32 s60, s60, 1
  s_lshr_b32 s61, s60, 1
  v_mfma_f32_16x16x32_bf16 v[172:175], a[216:219], v[48:51], v[172:175]
  ds_read_b128 a[100:103], v4 offset:25408
  s_andn2_b32 s61, 1, s61
  v_mfma_f32_16x16x32_bf16 v[176:179], a[232:235], v[48:51], v[176:179]
  ds_read_b128 a[116:119], v4 offset:25664
  v_cvt_pk_bf16_f32 v52, v64, v65
  v_cvt_pk_bf16_f32 v53, v66, v67
  v_mfma_f32_16x16x32_bf16 v[180:183], a[248:251], v[48:51], v[180:183]
  v_cvt_pk_bf16_f32 v54, v68, v69
  v_cvt_pk_bf16_f32 v55, v70, v71
  s_bitcmp1_b32 s60, 0
  s_cselect_b64 s[32:33], s[24:25], s[20:21]
  s_waitcnt lgkmcnt(15)
  v_mfma_f32_16x16x32_bf16 v[152:155], a[140:143], v[52:55], v[152:155]
  ds_read_b128 a[104:107], v4 offset:25472
  buffer_load_dwordx4 v6, s[12:15], s65 offen offset:2048  lds
  s_add_u32 m0, s63, 96
  v_mfma_f32_16x16x32_bf16 v[156:159], a[156:159], v[52:55], v[156:159]
  ds_read_b128 a[120:123], v4 offset:25728
  buffer_load_dwordx4 v6, s[12:15], s65 offen offset:3072  lds
  v_mfma_f32_16x16x32_bf16 v[160:163], a[172:175], v[52:55], v[160:163]
  ds_read_b128 a[108:111], v4 offset:25536
  s_add_u32 m0, s48, 0
  v_mfma_f32_16x16x32_bf16 v[164:167], a[188:191], v[52:55], v[164:167]
  ds_read_b128 a[124:127], v4 offset:25792
  buffer_load_dwordx4 v6, s[12:15], s66 offen offset:0  lds
  v_mfma_f32_16x16x32_bf16 v[168:171], a[204:207], v[52:55], v[168:171]
  v_fma_f32 v184, v216, v152, v184
  v_fma_f32 v185, v217, v153, v185
  v_mfma_f32_16x16x32_bf16 v[172:175], a[220:223], v[52:55], v[172:175]
  v_fma_f32 v186, v218, v154, v186
  v_fma_f32 v187, v219, v155, v187
  v_mfma_f32_16x16x32_bf16 v[176:179], a[236:239], v[52:55], v[176:179]
  v_cvt_pk_bf16_f32 v24, v184, v185
  v_fma_f32 v188, v220, v156, v188
  v_mfma_f32_16x16x32_bf16 v[180:183], a[252:255], v[52:55], v[180:183]
  v_fma_f32 v189, v221, v157, v189
  v_cvt_pk_bf16_f32 v25, v186, v187
  v_fma_f32 v190, v222, v158, v190
  v_fma_f32 v191, v223, v159, v191
  v_cvt_pk_bf16_f32 v26, v188, v189
  v_cvt_pk_bf16_f32 v27, v190, v191
  s_branch L_topf
L_B2l:
  buffer_load_dwordx4 v[72:75], v8, s[32:35], s57 offen offset:0 sc1
  buffer_load_dwordx4 v[76:79], v8, s[32:35], s58 offen offset:0 sc1
  buffer_load_dwordx4 v[80:83], v8, s[32:35], s59 offen offset:0 sc1
  ds_read_b128 a[128:131], v4 offset:33792
  v_lshlrev_b32 v196, 16, v30
  ds_read_b128 a[144:147], v4 offset:34048
  v_and_b32 v197, 0xffff0000, v30
  ds_read_b128 a[160:163], v4 offset:42240
  v_lshlrev_b32 v198, 16, v31
  ds_read_b128 a[176:179], v4 offset:42496
  v_and_b32 v199, 0xffff0000, v31
  ds_read_b128 a[192:195], v4 offset:50688
  v_lshlrev_b32 v200, 16, v32
  buffer_load_dwordx4 v[84:87], v8, s[32:35], s57 offen offset:1024 sc1
  buffer_load_dwordx4 v[88:91], v8, s[32:35], s58 offen offset:1024 sc1
  buffer_load_dwordx4 v[92:95], v8, s[32:35], s59 offen offset:1024 sc1
  ds_read_b128 a[208:211], v4 offset:50944
  v_and_b32 v201, 0xffff0000, v32
  ds_read_b128 a[224:227], v4 offset:59136
  v_lshlrev_b32 v202, 16, v33
  ds_read_b128 a[240:243], v4 offset:59392
  v_and_b32 v203, 0xffff0000, v33
  ds_read_b128 a[132:135], v4 offset:33856
  v_lshlrev_b32 v204, 16, v34
  ds_read_b128 a[148:151], v4 offset:34112
  v_and_b32 v205, 0xffff0000, v34
  ds_read_b128 a[164:167], v4 offset:42304
  v_lshlrev_b32 v206, 16, v35
  ds_read_b128 a[180:183], v4 offset:42560
  v_and_b32 v207, 0xffff0000, v35
  buffer_load_dwordx4 v[96:99], v8, s[32:35], s57 offen offset:2048 sc1
  buffer_load_dwordx4 v[100:103], v8, s[32:35], s58 offen offset:2048 sc1
  buffer_load_dwordx4 v[104:107], v8, s[32:35], s59 offen offset:2048 sc1
  ds_read_b128 a[196:199], v4 offset:50752
  v_lshlrev_b32 v208, 16, v36
  ds_read_b128 a[212:215], v4 offset:51008
  v_and_b32 v209, 0xffff0000, v36
  ds_read_b128 a[228:231], v4 offset:59200
  v_lshlrev_b32 v210, 16, v37
  ds_read_b128 a[244:247], v4 offset:59456
  v_and_b32 v211, 0xffff0000, v37
  ds_read_b128 a[136:139], v4 offset:33920
  v_lshlrev_b32 v212, 16, v38
  ds_read_b128 a[152:155], v4 offset:34176
  v_and_b32 v213, 0xffff0000, v38
  ds_read_b128 a[168:171], v4 offset:42368
  v_lshlrev_b32 v214, 16, v39
  buffer_load_dwordx4 v[108:111], v8, s[32:35], s57 offen offset:3072 sc1
  buffer_load_dwordx4 v[112:115], v8, s[32:35], s58 offen offset:3072 sc1
  buffer_load_dwordx4 v[116:119], v8, s[32:35], s59 offen offset:3072 sc1
  ds_read_b128 a[184:187], v4 offset:42624
  v_and_b32 v215, 0xffff0000, v39
L_Cl:
  s_waitcnt vmcnt(9)
  v_mfma_f32_16x16x16_bf16 v[56:59], v[16:17], v[72:73], v[120:123]
  v_bitop3_b32 v10, v72, v76, s61 bitop3:0x7e
  v_bitop3_b32 v10, v10, v80, s61 bitop3:0xf6
  v_mfma_f32_16x16x16_bf16 v[60:63], v[16:17], v[74:75], v[124:127]
  v_and_b32 v10, 1, v10
  v_cmp_ne_u32 vcc, 0, v10
  v_mfma_f32_16x16x16_bf16 v[56:59], v[16:17], v[76:77], v[56:59]
  ds_read_b128 a[200:203], v4 offset:50816
  v_mfma_f32_16x16x16_bf16 v[60:63], v[16:17], v[78:79], v[60:63]
  ds_read_b128 a[216:219], v4 offset:51072
  v_mfma_f32_16x16x16_bf16 v[56:59], v[16:17], v[80:81], v[56:59]
  ds_read_b128 a[232:235], v4 offset:59264
  v_mfma_f32_16x16x16_bf16 v[60:63], v[16:17], v[82:83], v[60:63]
  s_cbranch_vccnz L_rt0l
L_go0l:
  s_waitcnt vmcnt(6)
  v_mfma_f32_16x16x16_bf16 v[64:67], v[16:17], v[84:85], v[128:131]
  v_bitop3_b32 v10, v84, v88, s61 bitop3:0x7e
  v_bitop3_b32 v10, v10, v92, s61 bitop3:0xf6
  v_mfma_f32_16x16x16_bf16 v[68:71], v[16:17], v[86:87], v[132:135]
  v_and_b32 v10, 1, v10
  v_cmp_ne_u32 vcc, 0, v10
  v_mfma_f32_16x16x16_bf16 v[64:67], v[16:17], v[88:89], v[64:67]
  v_cvt_pk_bf16_f32 v40, v56, v57
  v_cvt_pk_bf16_f32 v41, v58, v59
  v_mfma_f32_16x16x16_bf16 v[68:71], v[16:17], v[90:91], v[68:71]
  v_cvt_pk_bf16_f32 v42, v60, v61
  v_cvt_pk_bf16_f32 v43, v62, v63
  v_mfma_f32_16x16x16_bf16 v[64:67], v[16:17], v[92:93], v[64:67]
  ds_read_b128 a[248:251], v4 offset:59520
  v_mfma_f32_16x16x16_bf16 v[68:71], v[16:17], v[94:95], v[68:71]
  s_cbranch_vccnz L_rt1l
L_go1l:
  s_waitcnt lgkmcnt(15)
  v_mfma_f32_16x16x32_bf16 v[152:155], a[128:131], v[40:43], v[152:155]
  ds_read_b128 a[140:143], v4 offset:33984
  v_mfma_f32_16x16x32_bf16 v[156:159], a[144:147], v[40:43], v[156:159]
  ds_read_b128 a[156:159], v4 offset:34240
  v_mfma_f32_16x16x32_bf16 v[160:163], a[160:163], v[40:43], v[160:163]
  ds_read_b128 a[172:175], v4 offset:42432
  v_mfma_f32_16x16x32_bf16 v[164:167], a[176:179], v[40:43], v[164:167]
  v_cvt_pk_bf16_f32 v44, v64, v65
  v_cvt_pk_bf16_f32 v45, v66, v67
  v_mfma_f32_16x16x32_bf16 v[168:171], a[192:195], v[40:43], v[168:171]
  v_cvt_pk_bf16_f32 v46, v68, v69
  v_cvt_pk_bf16_f32 v47, v70, v71
  v_mfma_f32_16x16x32_bf16 v[172:175], a[208:211], v[40:43], v[172:175]
  ds_read_b128 a[188:191], v4 offset:42688
  v_mfma_f32_16x16x32_bf16 v[176:179], a[224:227], v[40:43], v[176:179]
  ds_read_b128 a[204:207], v4 offset:50880
  v_mfma_f32_16x16x32_bf16 v[180:183], a[240:243], v[40:43], v[180:183]
  ds_read_b128 a[220:223], v4 offset:51136
  s_waitcnt vmcnt(3)
  v_mfma_f32_16x16x16_bf16 v[56:59], v[16:17], v[96:97], v[136:139]
  v_bitop3_b32 v10, v96, v100, s61 bitop3:0x7e
  v_bitop3_b32 v10, v10, v104, s61 bitop3:0xf6
  v_mfma_f32_16x16x16_bf16 v[60:63], v[16:17], v[98:99], v[140:143]
  v_and_b32 v10, 1, v10
  v_cmp_ne_u32 vcc, 0, v10
  v_mfma_f32_16x16x16_bf16 v[56:59], v[16:17], v[100:101], v[56:59]
  ds_read_b128 a[236:239], v4 offset:59328
  v_mfma_f32_16x16x16_bf16 v[60:63], v[16:17], v[102:103], v[60:63]
  ds_read_b128 a[252:255], v4 offset:59584
  v_mfma_f32_16x16x16_bf16 v[56:59], v[16:17], v[104:105], v[56:59]
  v_mfma_f32_16x16x16_bf16 v[60:63], v[16:17], v[106:107], v[60:63]
  s_cbranch_vccnz L_rt2l
L_go2l:
  s_waitcnt lgkmcnt(15)
  v_mfma_f32_16x16x32_bf16 v[152:155], a[132:135], v[44:47], v[152:155]
  v_mfma_f32_16x16x32_bf16 v[156:159], a[148:151], v[44:47], v[156:159]
  v_mfma_f32_16x16x32_bf16 v[160:163], a[164:167], v[44:47], v[160:163]
  v_mfma_f32_16x16x32_bf16 v[164:167], a[180:183], v[44:47], v[164:167]
  s_nop 0
  v_cvt_pk_bf16_f32 v48, v56, v57
  v_cvt_pk_bf16_f32 v49, v58, v59
  v_mfma_f32_16x16x32_bf16 v[168:171], a[196:199], v[44:47], v[168:171]
  v_cvt_pk_bf16_f32 v50, v60, v61
  v_cvt_pk_bf16_f32 v51, v62, v63
  v_mfma_f32_16x16x32_bf16 v[172:175], a[212:215], v[44:47], v[172:175]
  v_mfma_f32_16x16x32_bf16 v[176:179], a[228:231], v[44:47], v[176:179]
  v_mfma_f32_16x16x32_bf16 v[180:183], a[244:247], v[44:47], v[180:183]
  s_waitcnt lgkmcnt(8)
  v_mfma_f32_16x16x32_bf16 v[152:155], a[136:139], v[48:51], v[152:155]
  v_mfma_f32_16x16x32_bf16 v[156:159], a[152:155], v[48:51], v[156:159]
  v_mfma_f32_16x16x32_bf16 v[160:163], a[168:171], v[48:51], v[160:163]
  v_mfma_f32_16x16x32_bf16 v[164:167], a[184:187], v[48:51], v[164:167]
  s_waitcnt vmcnt(0)
  v_mfma_f32_16x16x16_bf16 v[64:67], v[16:17], v[108:109], v[144:147]
  v_bitop3_b32 v10, v108, v112, s61 bitop3:0x7e
  v_bitop3_b32 v10, v10, v116, s61 bitop3:0xf6
  v_mfma_f32_16x16x16_bf16 v[68:71], v[16:17], v[110:111], v[148:151]
  v_and_b32 v10, 1, v10
  v_cmp_ne_u32 vcc, 0, v10
  v_mfma_f32_16x16x16_bf16 v[64:67], v[16:17], v[112:113], v[64:67]
  v_mfma_f32_16x16x16_bf16 v[68:71], v[16:17], v[114:115], v[68:71]
  v_mfma_f32_16x16x16_bf16 v[64:67], v[16:17], v[116:117], v[64:67]
  v_mfma_f32_16x16x16_bf16 v[68:71], v[16:17], v[118:119], v[68:71]
  s_cbranch_vccnz L_rt3l
L_go3l:
  v_mfma_f32_16x16x32_bf16 v[168:171], a[200:203], v[48:51], v[168:171]
  s_add_u32 s60, s60, 1
  s_lshr_b32 s61, s60, 1
  v_mfma_f32_16x16x32_bf16 v[172:175], a[216:219], v[48:51], v[172:175]
  s_andn2_b32 s61, 1, s61
  v_mfma_f32_16x16x32_bf16 v[176:179], a[232:235], v[48:51], v[176:179]
  v_cvt_pk_bf16_f32 v52, v64, v65
  v_cvt_pk_bf16_f32 v53, v66, v67
  v_mfma_f32_16x16x32_bf16 v[180:183], a[248:251], v[48:51], v[180:183]
  v_cvt_pk_bf16_f32 v54, v68, v69
  v_cvt_pk_bf16_f32 v55, v70, v71
  s_bitcmp1_b32 s60, 0
  s_cselect_b64 s[32:33], s[24:25], s[20:21]
  s_waitcnt lgkmcnt(0)
  v_mfma_f32_16x16x32_bf16 v[152:155], a[140:143], v[52:55], v[152:155]
  v_mfma_f32_16x16x32_bf16 v[156:159], a[156:159], v[52:55], v[156:159]
  v_mfma_f32_16x16x32_bf16 v[160:163], a[172:175], v[52:55], v[160:163]
  v_mfma_f32_16x16x32_bf16 v[164:167], a[188:191], v[52:55], v[164:167]
  s_nop 3
  v_mfma_f32_16x16x32_bf16 v[168:171], a[204:207], v[52:55], v[168:171]
  v_fma_f32 v184, v216, v152, v184
  v_fma_f32 v185, v217, v153, v185
  v_mfma_f32_16x16x32_bf16 v[172:175], a[220:223], v[52:55], v[172:175]
  v_fma_f32 v186, v218, v154, v186
  v_fma_f32 v187, v219, v155, v187
  v_mfma_f32_16x16x32_bf16 v[176:179], a[236:239], v[52:55], v[176:179]
  v_cvt_pk_bf16_f32 v24, v184, v185
  v_fma_f32 v188, v220, v156, v188
  v_mfma_f32_16x16x32_bf16 v[180:183], a[252:255], v[52:55], v[180:183]
  v_fma_f32 v189, v221, v157, v189
  v_cvt_pk_bf16_f32 v25, v186, v187
  v_fma_f32 v190, v222, v158, v190
  v_fma_f32 v191, v223, v159, v191
  v_cvt_pk_bf16_f32 v26, v188, v189
  v_cvt_pk_bf16_f32 v27, v190, v191
L_epi:
  ds_write_b128 v18, v[24:27] offset:0
  v_fma_f32 v192, v224, v160, v192
  v_fma_f32 v193, v225, v161, v193
  v_fma_f32 v194, v226, v162, v194
  v_fma_f32 v195, v227, v163, v195
  v_cvt_pk_bf16_f32 v28, v192, v193
  v_fma_f32 v196, v228, v164, v196
  v_fma_f32 v197, v229, v165, v197
  v_cvt_pk_bf16_f32 v29, v194, v195
  v_fma_f32 v198, v230, v166, v198
  v_fma_f32 v199, v231, v167, v199
  v_cvt_pk_bf16_f32 v30, v196, v197
  v_cvt_pk_bf16_f32 v31, v198, v199
  ds_write_b128 v18, v[28:31] offset:64
  v_fma_f32 v200, v232, v168, v200
  v_fma_f32 v201, v233, v169, v201
  v_fma_f32 v202, v234, v170, v202
  v_fma_f32 v203, v235, v171, v203
  v_cvt_pk_bf16_f32 v32, v200, v201
  v_fma_f32 v204, v236, v172, v204
  v_fma_f32 v205, v237, v173, v205
  v_cvt_pk_bf16_f32 v33, v202, v203
  v_fma_f32 v206, v238, v174, v206
  v_fma_f32 v207, v239, v175, v207
  v_cvt_pk_bf16_f32 v34, v204, v205
  v_cvt_pk_bf16_f32 v35, v206, v207
  ds_write_b128 v18, v[32:35] offset:128
  v_fma_f32 v208, v240, v176, v208
  v_fma_f32 v209, v241, v177, v209
  v_fma_f32 v210, v242, v178, v210
  v_fma_f32 v211, v243, v179, v211
  v_cvt_pk_bf16_f32 v36, v208, v209
  v_fma_f32 v212, v244, v180, v212
  v_fma_f32 v213, v245, v181, v213
  v_cvt_pk_bf16_f32 v37, v210, v211
  v_fma_f32 v214, v246, v182, v214
  v_fma_f32 v215, v247, v183, v215
  v_cvt_pk_bf16_f32 v38, v212, v213
  v_cvt_pk_bf16_f32 v39, v214, v215
  ds_write_b128 v18, v[36:39] offset:192
  ds_read_b128 v[72:75], v19 offset:0
  ds_read_b128 v[76:79], v19 offset:1056
  ds_read_b128 v[80:83], v19 offset:2112
  ds_read_b128 v[84:87], v19 offset:3168
  s_waitcnt lgkmcnt(3)
  buffer_store_dwordx4 v[72:75], v8, s[20:23], s56 offen offset:0
  s_waitcnt lgkmcnt(2)
  buffer_store_dwordx4 v[76:79], v8, s[20:23], s56 offen offset:1024
  s_waitcnt lgkmcnt(1)
  buffer_store_dwordx4 v[80:83], v8, s[20:23], s56 offen offset:2048
  s_waitcnt lgkmcnt(0)
  buffer_store_dwordx4 v[84:87], v8, s[20:23], s56 offen offset:3072
L_end:
  s_endpgm
L_rt0f:
L_rf0f:
  buffer_load_dwordx4 v[72:75], v8, s[32:35], s57 offen offset:0 sc1
  buffer_load_dwordx4 v[76:79], v8, s[32:35], s58 offen offset:0 sc1
  buffer_load_dwordx4 v[80:83], v8, s[32:35], s59 offen offset:0 sc1
  buffer_load_dwordx4 v[84:87], v8, s[32:35], s57 offen offset:1024 sc1
  buffer_load_dwordx4 v[88:91], v8, s[32:35], s58 offen offset:1024 sc1
  buffer_load_dwordx4 v[92:95], v8, s[32:35], s59 offen offset:1024 sc1
  buffer_load_dwordx4 v[96:99], v8, s[32:35], s57 offen offset:2048 sc1
  buffer_load_dwordx4 v[100:103], v8, s[32:35], s58 offen offset:2048 sc1
  buffer_load_dwordx4 v[104:107], v8, s[32:35], s59 offen offset:2048 sc1
  buffer_load_dwordx4 v[108:111], v8, s[32:35], s57 offen offset:3072 sc1
  buffer_load_dwordx4 v[112:115], v8, s[32:35], s58 offen offset:3072 sc1
  buffer_load_dwordx4 v[116:119], v8, s[32:35], s59 offen offset:3072 sc1
  s_waitcnt vmcnt(9)
  v_bitop3_b32 v10, v72, v76, s61 bitop3:0x7e
  v_bitop3_b32 v10, v10, v80, s61 bitop3:0xf6
  v_and_b32 v10, 1, v10
  v_cmp_ne_u32 vcc, 0, v10
  s_cbranch_vccnz L_pl0f
L_rs0f:
  v_mfma_f32_16x16x16_bf16 v[56:59], v[16:17], v[72:73], v[120:123]
  v_mfma_f32_16x16x16_bf16 v[60:63], v[16:17], v[74:75], v[124:127]
  v_mfma_f32_16x16x16_bf16 v[56:59], v[16:17], v[76:77], v[56:59]
  v_mfma_f32_16x16x16_bf16 v[60:63], v[16:17], v[78:79], v[60:63]
  v_mfma_f32_16x16x16_bf16 v[56:59], v[16:17], v[80:81], v[56:59]
  v_mfma_f32_16x16x16_bf16 v[60:63], v[16:17], v[82:83], v[60:63]
  s_branch L_go0f
L_pl0f:
  s_mov_b64 exec, 1
L_pp0f:
  buffer_load_dword v72, v8, s[32:35], s57 offen offset:0 sc1
  buffer_load_dword v76, v8, s[32:35], s58 offen offset:0 sc1
  buffer_load_dword v80, v8, s[32:35], s59 offen offset:0 sc1
  s_add_u32 s71, s71, 1
  s_waitcnt vmcnt(0)
  v_bitop3_b32 v10, v72, v76, s61 bitop3:0x7e
  v_bitop3_b32 v10, v10, v80, s61 bitop3:0xf6
  v_and_b32 v10, 1, v10
  v_cmp_ne_u32 vcc, 0, v10
  s_cmp_gt_u32 s71, 0x40000
  s_cbranch_scc1 L_gu0f
  s_cbranch_vccnz L_pp0f
  s_mov_b64 exec, -1
  s_branch L_rf0f
L_gu0f:
  s_mov_b64 exec, -1
  s_branch L_rs0f
L_rt1f:
L_rf1f:
  buffer_load_dwordx4 v[84:87], v8, s[32:35], s57 offen offset:1024 sc1
  buffer_load_dwordx4 v[88:91], v8, s[32:35], s58 offen offset:1024 sc1
  buffer_load_dwordx4 v[92:95], v8, s[32:35], s59 offen offset:1024 sc1
  buffer_load_dwordx4 v[96:99], v8, s[32:35], s57 offen offset:2048 sc1
  buffer_load_dwordx4 v[100:103], v8, s[32:35], s58 offen offset:2048 sc1
  buffer_load_dwordx4 v[104:107], v8, s[32:35], s59 offen offset:2048 sc1
  buffer_load_dwordx4 v[108:111], v8, s[32:35], s57 offen offset:3072 sc1
  buffer_load_dwordx4 v[112:115], v8, s[32:35], s58 offen offset:3072 sc1
  buffer_load_dwordx4 v[116:119], v8, s[32:35], s59 offen offset:3072 sc1
  s_waitcnt vmcnt(6)
  v_bitop3_b32 v10, v84, v88, s61 bitop3:0x7e
  v_bitop3_b32 v10, v10, v92, s61 bitop3:0xf6
  v_and_b32 v10, 1, v10
  v_cmp_ne_u32 vcc, 0, v10
  s_cbranch_vccnz L_pl1f
L_rs1f:
  v_mfma_f32_16x16x16_bf16 v[64:67], v[16:17], v[84:85], v[128:131]
  v_mfma_f32_16x16x16_bf16 v[68:71], v[16:17], v[86:87], v[132:135]
  v_mfma_f32_16x16x16_bf16 v[64:67], v[16:17], v[88:89], v[64:67]
  v_mfma_f32_16x16x16_bf16 v[68:71], v[16:17], v[90:91], v[68:71]
  v_mfma_f32_16x16x16_bf16 v[64:67], v[16:17], v[92:93], v[64:67]
  v_mfma_f32_16x16x16_bf16 v[68:71], v[16:17], v[94:95], v[68:71]
  s_branch L_go1f
L_pl1f:
  s_mov_b64 exec, 1
L_pp1f:
  buffer_load_dword v84, v8, s[32:35], s57 offen offset:1024 sc1
  buffer_load_dword v88, v8, s[32:35], s58 offen offset:1024 sc1
  buffer_load_dword v92, v8, s[32:35], s59 offen offset:1024 sc1
  s_add_u32 s71, s71, 1
  s_waitcnt vmcnt(0)
  v_bitop3_b32 v10, v84, v88, s61 bitop3:0x7e
  v_bitop3_b32 v10, v10, v92, s61 bitop3:0xf6
  v_and_b32 v10, 1, v10
  v_cmp_ne_u32 vcc, 0, v10
  s_cmp_gt_u32 s71, 0x40000
  s_cbranch_scc1 L_gu1f
  s_cbranch_vccnz L_pp1f
  s_mov_b64 exec, -1
  s_branch L_rf1f
L_gu1f:
  s_mov_b64 exec, -1
  s_branch L_rs1f
L_rt2f:
L_rf2f:
  buffer_load_dwordx4 v[96:99], v8, s[32:35], s57 offen offset:2048 sc1
  buffer_load_dwordx4 v[100:103], v8, s[32:35], s58 offen offset:2048 sc1
  buffer_load_dwordx4 v[104:107], v8, s[32:35], s59 offen offset:2048 sc1
  buffer_load_dwordx4 v[108:111], v8, s[32:35], s57 offen offset:3072 sc1
  buffer_load_dwordx4 v[112:115], v8, s[32:35], s58 offen offset:3072 sc1
  buffer_load_dwordx4 v[116:119], v8, s[32:35], s59 offen offset:3072 sc1
  s_mov_b64 exec, 1
  buffer_load_dword v13, v8, s[32:35], s56 offen
  buffer_load_dword v13, v8, s[32:35], s56 offen
  buffer_load_dword v13, v8, s[32:35], s56 offen
  buffer_load_dword v13, v8, s[32:35], s56 offen
  buffer_load_dword v13, v8, s[32:35], s56 offen
  s_mov_b64 exec, -1
  s_waitcnt vmcnt(8)
  v_bitop3_b32 v10, v96, v100, s61 bitop3:0x7e
  v_bitop3_b32 v10, v10, v104, s61 bitop3:0xf6
  v_and_b32 v10, 1, v10
  v_cmp_ne_u32 vcc, 0, v10
  s_cbranch_vccnz L_pl2f
L_rs2f:
  v_mfma_f32_16x16x16_bf16 v[56:59], v[16:17], v[96:97], v[136:139]
  v_mfma_f32_16x16x16_bf16 v[60:63], v[16:17], v[98:99], v[140:143]
  v_mfma_f32_16x16x16_bf16 v[56:59], v[16:17], v[100:101], v[56:59]
  v_mfma_f32_16x16x16_bf16 v[60:63], v[16:17], v[102:103], v[60:63]
  v_mfma_f32_16x16x16_bf16 v[56:59], v[16:17], v[104:105], v[56:59]
  v_mfma_f32_16x16x16_bf16 v[60:63], v[16:17], v[106:107], v[60:63]
  s_branch L_go2f
L_pl2f:
  s_mov_b64 exec, 1
L_pp2f:
  buffer_load_dword v96, v8, s[32:35], s57 offen offset:2048 sc1
  buffer_load_dword v100, v8, s[32:35], s58 offen offset:2048 sc1
  buffer_load_dword v104, v8, s[32:35], s59 offen offset:2048 sc1
  s_add_u32 s71, s71, 1
  s_waitcnt vmcnt(0)
  v_bitop3_b32 v10, v96, v100, s61 bitop3:0x7e
  v_bitop3_b32 v10, v10, v104, s61 bitop3:0xf6
  v_and_b32 v10, 1, v10
  v_cmp_ne_u32 vcc, 0, v10
  s_cmp_gt_u32 s71, 0x40000
  s_cbranch_scc1 L_gu2f
  s_cbranch_vccnz L_pp2f
  s_mov_b64 exec, -1
  s_branch L_rf2f
L_gu2f:
  s_mov_b64 exec, -1
  s_branch L_rs2f
L_rt3f:
L_rf3f:
  buffer_load_dwordx4 v[108:111], v8, s[32:35], s57 offen offset:3072 sc1
  buffer_load_dwordx4 v[112:115], v8, s[32:35], s58 offen offset:3072 sc1
  buffer_load_dwordx4 v[116:119], v8, s[32:35], s59 offen offset:3072 sc1
  s_waitcnt vmcnt(0)
  v_bitop3_b32 v10, v108, v112, s61 bitop3:0x7e
  v_bitop3_b32 v10, v10, v116, s61 bitop3:0xf6
  v_and_b32 v10, 1, v10
  v_cmp_ne_u32 vcc, 0, v10
  s_cbranch_vccnz L_pl3f
L_rs3f:
  v_mfma_f32_16x16x16_bf16 v[64:67], v[16:17], v[108:109], v[144:147]
  v_mfma_f32_16x16x16_bf16 v[68:71], v[16:17], v[110:111], v[148:151]
  v_mfma_f32_16x16x16_bf16 v[64:67], v[16:17], v[112:113], v[64:67]
  v_mfma_f32_16x16x16_bf16 v[68:71], v[16:17], v[114:115], v[68:71]
  v_mfma_f32_16x16x16_bf16 v[64:67], v[16:17], v[116:117], v[64:67]
  v_mfma_f32_16x16x16_bf16 v[68:71], v[16:17], v[118:119], v[68:71]
  s_branch L_go3f
L_pl3f:
  s_mov_b64 exec, 1
L_pp3f:
  buffer_load_dword v108, v8, s[32:35], s57 offen offset:3072 sc1
  buffer_load_dword v112, v8, s[32:35], s58 offen offset:3072 sc1
  buffer_load_dword v116, v8, s[32:35], s59 offen offset:3072 sc1
  s_add_u32 s71, s71, 1
  s_waitcnt vmcnt(0)
  v_bitop3_b32 v10, v108, v112, s61 bitop3:0x7e
  v_bitop3_b32 v10, v10, v116, s61 bitop3:0xf6
  v_and_b32 v10, 1, v10
  v_cmp_ne_u32 vcc, 0, v10
  s_cmp_gt_u32 s71, 0x40000
  s_cbranch_scc1 L_gu3f
  s_cbranch_vccnz L_pp3f
  s_mov_b64 exec, -1
  s_branch L_rf3f
L_gu3f:
  s_mov_b64 exec, -1
  s_branch L_rs3f
L_rt0l:
L_rf0l:
  buffer_load_dwordx4 v[72:75], v8, s[32:35], s57 offen offset:0 sc1
  buffer_load_dwordx4 v[76:79], v8, s[32:35], s58 offen offset:0 sc1
  buffer_load_dwordx4 v[80:83], v8, s[32:35], s59 offen offset:0 sc1
  buffer_load_dwordx4 v[84:87], v8, s[32:35], s57 offen offset:1024 sc1
  buffer_load_dwordx4 v[88:91], v8, s[32:35], s58 offen offset:1024 sc1
  buffer_load_dwordx4 v[92:95], v8, s[32:35], s59 offen offset:1024 sc1
  buffer_load_dwordx4 v[96:99], v8, s[32:35], s57 offen offset:2048 sc1
  buffer_load_dwordx4 v[100:103], v8, s[32:35], s58 offen offset:2048 sc1
  buffer_load_dwordx4 v[104:107], v8, s[32:35], s59 offen offset:2048 sc1
  buffer_load_dwordx4 v[108:111], v8, s[32:35], s57 offen offset:3072 sc1
  buffer_load_dwordx4 v[112:115], v8, s[32:35], s58 offen offset:3072 sc1
  buffer_load_dwordx4 v[116:119], v8, s[32:35], s59 offen offset:3072 sc1
  s_waitcnt vmcnt(9)
  v_bitop3_b32 v10, v72, v76, s61 bitop3:0x7e
  v_bitop3_b32 v10, v10, v80, s61 bitop3:0xf6
  v_and_b32 v10, 1, v10
  v_cmp_ne_u32 vcc, 0, v10
  s_cbranch_vccnz L_pl0l
L_rs0l:
  v_mfma_f32_16x16x16_bf16 v[56:59], v[16:17], v[72:73], v[120:123]
  v_mfma_f32_16x16x16_bf16 v[60:63], v[16:17], v[74:75], v[124:127]
  v_mfma_f32_16x16x16_bf16 v[56:59], v[16:17], v[76:77], v[56:59]
  v_mfma_f32_16x16x16_bf16 v[60:63], v[16:17], v[78:79], v[60:63]
  v_mfma_f32_16x16x16_bf16 v[56:59], v[16:17], v[80:81], v[56:59]
  v_mfma_f32_16x16x16_bf16 v[60:63], v[16:17], v[82:83], v[60:63]
  s_branch L_go0l
L_pl0l:
  s_mov_b64 exec, 1
L_pp0l:
  buffer_load_dword v72, v8, s[32:35], s57 offen offset:0 sc1
  buffer_load_dword v76, v8, s[32:35], s58 offen offset:0 sc1
  buffer_load_dword v80, v8, s[32:35], s59 offen offset:0 sc1
  s_add_u32 s71, s71, 1
  s_waitcnt vmcnt(0)
  v_bitop3_b32 v10, v72, v76, s61 bitop3:0x7e
  v_bitop3_b32 v10, v10, v80, s61 bitop3:0xf6
  v_and_b32 v10, 1, v10
  v_cmp_ne_u32 vcc, 0, v10
  s_cmp_gt_u32 s71, 0x40000
  s_cbranch_scc1 L_gu0l
  s_cbranch_vccnz L_pp0l
  s_mov_b64 exec, -1
  s_branch L_rf0l
L_gu0l:
  s_mov_b64 exec, -1
  s_branch L_rs0l
L_rt1l:
L_rf1l:
  buffer_load_dwordx4 v[84:87], v8, s[32:35], s57 offen offset:1024 sc1
  buffer_load_dwordx4 v[88:91], v8, s[32:35], s58 offen offset:1024 sc1
  buffer_load_dwordx4 v[92:95], v8, s[32:35], s59 offen offset:1024 sc1
  buffer_load_dwordx4 v[96:99], v8, s[32:35], s57 offen offset:2048 sc1
  buffer_load_dwordx4 v[100:103], v8, s[32:35], s58 offen offset:2048 sc1
  buffer_load_dwordx4 v[104:107], v8, s[32:35], s59 offen offset:2048 sc1
  buffer_load_dwordx4 v[108:111], v8, s[32:35], s57 offen offset:3072 sc1
  buffer_load_dwordx4 v[112:115], v8, s[32:35], s58 offen offset:3072 sc1
  buffer_load_dwordx4 v[116:119], v8, s[32:35], s59 offen offset:3072 sc1
  s_waitcnt vmcnt(6)
  v_bitop3_b32 v10, v84, v88, s61 bitop3:0x7e
  v_bitop3_b32 v10, v10, v92, s61 bitop3:0xf6
  v_and_b32 v10, 1, v10
  v_cmp_ne_u32 vcc, 0, v10
  s_cbranch_vccnz L_pl1l
L_rs1l:
  v_mfma_f32_16x16x16_bf16 v[64:67], v[16:17], v[84:85], v[128:131]
  v_mfma_f32_16x16x16_bf16 v[68:71], v[16:17], v[86:87], v[132:135]
  v_mfma_f32_16x16x16_bf16 v[64:67], v[16:17], v[88:89], v[64:67]
  v_mfma_f32_16x16x16_bf16 v[68:71], v[16:17], v[90:91], v[68:71]
  v_mfma_f32_16x16x16_bf16 v[64:67], v[16:17], v[92:93], v[64:67]
  v_mfma_f32_16x16x16_bf16 v[68:71], v[16:17], v[94:95], v[68:71]
  s_branch L_go1l
L_pl1l:
  s_mov_b64 exec, 1
L_pp1l:
  buffer_load_dword v84, v8, s[32:35], s57 offen offset:1024 sc1
  buffer_load_dword v88, v8, s[32:35], s58 offen offset:1024 sc1
  buffer_load_dword v92, v8, s[32:35], s59 offen offset:1024 sc1
  s_add_u32 s71, s71, 1
  s_waitcnt vmcnt(0)
  v_bitop3_b32 v10, v84, v88, s61 bitop3:0x7e
  v_bitop3_b32 v10, v10, v92, s61 bitop3:0xf6
  v_and_b32 v10, 1, v10
  v_cmp_ne_u32 vcc, 0, v10
  s_cmp_gt_u32 s71, 0x40000
  s_cbranch_scc1 L_gu1l
  s_cbranch_vccnz L_pp1l
  s_mov_b64 exec, -1
  s_branch L_rf1l
L_gu1l:
  s_mov_b64 exec, -1
  s_branch L_rs1l
L_rt2l:
L_rf2l:
  buffer_load_dwordx4 v[96:99], v8, s[32:35], s57 offen offset:2048 sc1
  buffer_load_dwordx4 v[100:103], v8, s[32:35], s58 offen offset:2048 sc1
  buffer_load_dwordx4 v[104:107], v8, s[32:35], s59 offen offset:2048 sc1
  buffer_load_dwordx4 v[108:111], v8, s[32:35], s57 offen offset:3072 sc1
  buffer_load_dwordx4 v[112:115], v8, s[32:35], s58 offen offset:3072 sc1
  buffer_load_dwordx4 v[116:119], v8, s[32:35], s59 offen offset:3072 sc1
  s_waitcnt vmcnt(3)
  v_bitop3_b32 v10, v96, v100, s61 bitop3:0x7e
  v_bitop3_b32 v10, v10, v104, s61 bitop3:0xf6
  v_and_b32 v10, 1, v10
  v_cmp_ne_u32 vcc, 0, v10
  s_cbranch_vccnz L_pl2l
L_rs2l:
  v_mfma_f32_16x16x16_bf16 v[56:59], v[16:17], v[96:97], v[136:139]
  v_mfma_f32_16x16x16_bf16 v[60:63], v[16:17], v[98:99], v[140:143]
  v_mfma_f32_16x16x16_bf16 v[56:59], v[16:17], v[100:101], v[56:59]
  v_mfma_f32_16x16x16_bf16 v[60:63], v[16:17], v[102:103], v[60:63]
  v_mfma_f32_16x16x16_bf16 v[56:59], v[16:17], v[104:105], v[56:59]
  v_mfma_f32_16x16x16_bf16 v[60:63], v[16:17], v[106:107], v[60:63]
  s_branch L_go2l
L_pl2l:
  s_mov_b64 exec, 1
L_pp2l:
  buffer_load_dword v96, v8, s[32:35], s57 offen offset:2048 sc1
  buffer_load_dword v100, v8, s[32:35], s58 offen offset:2048 sc1
  buffer_load_dword v104, v8, s[32:35], s59 offen offset:2048 sc1
  s_add_u32 s71, s71, 1
  s_waitcnt vmcnt(0)
  v_bitop3_b32 v10, v96, v100, s61 bitop3:0x7e
  v_bitop3_b32 v10, v10, v104, s61 bitop3:0xf6
  v_and_b32 v10, 1, v10
  v_cmp_ne_u32 vcc, 0, v10
  s_cmp_gt_u32 s71, 0x40000
  s_cbranch_scc1 L_gu2l
  s_cbranch_vccnz L_pp2l
  s_mov_b64 exec, -1
  s_branch L_rf2l
L_gu2l:
  s_mov_b64 exec, -1
  s_branch L_rs2l
L_rt3l:
L_rf3l:
  buffer_load_dwordx4 v[108:111], v8, s[32:35], s57 offen offset:3072 sc1
  buffer_load_dwordx4 v[112:115], v8, s[32:35], s58 offen offset:3072 sc1
  buffer_load_dwordx4 v[116:119], v8, s[32:35], s59 offen offset:3072 sc1
  s_waitcnt vmcnt(0)
  v_bitop3_b32 v10, v108, v112, s61 bitop3:0x7e
  v_bitop3_b32 v10, v10, v116, s61 bitop3:0xf6
  v_and_b32 v10, 1, v10
  v_cmp_ne_u32 vcc, 0, v10
  s_cbranch_vccnz L_pl3l
L_rs3l:
  v_mfma_f32_16x16x16_bf16 v[64:67], v[16:17], v[108:109], v[144:147]
  v_mfma_f32_16x16x16_bf16 v[68:71], v[16:17], v[110:111], v[148:151]
  v_mfma_f32_16x16x16_bf16 v[64:67], v[16:17], v[112:113], v[64:67]
  v_mfma_f32_16x16x16_bf16 v[68:71], v[16:17], v[114:115], v[68:71]
  v_mfma_f32_16x16x16_bf16 v[64:67], v[16:17], v[116:117], v[64:67]
  v_mfma_f32_16x16x16_bf16 v[68:71], v[16:17], v[118:119], v[68:71]
  s_branch L_go3l
L_pl3l:
  s_mov_b64 exec, 1
L_pp3l:
  buffer_load_dword v108, v8, s[32:35], s57 offen offset:3072 sc1
  buffer_load_dword v112, v8, s[32:35], s58 offen offset:3072 sc1
  buffer_load_dword v116, v8, s[32:35], s59 offen offset:3072 sc1
  s_add_u32 s71, s71, 1
  s_waitcnt vmcnt(0)
  v_bitop3_b32 v10, v108, v112, s61 bitop3:0x7e
  v_bitop3_b32 v10, v10, v116, s61 bitop3:0xf6
  v_and_b32 v10, 1, v10
  v_cmp_ne_u32 vcc, 0, v10
  s_cmp_gt_u32 s71, 0x40000
  s_cbranch_scc1 L_gu3l
  s_cbranch_vccnz L_pp3l
  s_mov_b64 exec, -1
  s_branch L_rf3l
L_gu3l:
  s_mov_b64 exec, -1
  s_branch L_rs3l
L_slowinit:
  s_waitcnt lgkmcnt(0)
  v_lshlrev_b32 v216, 16, v24
  v_and_b32 v217, 0xffff0000, v24
  v_lshlrev_b32 v218, 16, v25
  v_and_b32 v219, 0xffff0000, v25
  v_lshlrev_b32 v220, 16, v26
  v_and_b32 v221, 0xffff0000, v26
  v_lshlrev_b32 v222, 16, v27
  v_and_b32 v223, 0xffff0000, v27
  v_lshlrev_b32 v184, 16, v24
  v_and_b32 v185, 0xffff0000, v24
  v_lshlrev_b32 v186, 16, v25
  v_and_b32 v187, 0xffff0000, v25
  v_lshlrev_b32 v188, 16, v26
  v_and_b32 v189, 0xffff0000, v26
  v_lshlrev_b32 v190, 16, v27
  v_and_b32 v191, 0xffff0000, v27
  v_lshlrev_b32 v224, 16, v28
  v_and_b32 v225, 0xffff0000, v28
  v_lshlrev_b32 v226, 16, v29
  v_and_b32 v227, 0xffff0000, v29
  v_lshlrev_b32 v228, 16, v30
  v_and_b32 v229, 0xffff0000, v30
  v_lshlrev_b32 v230, 16, v31
  v_and_b32 v231, 0xffff0000, v31
  v_lshlrev_b32 v192, 16, v28
  v_and_b32 v193, 0xffff0000, v28
  v_lshlrev_b32 v194, 16, v29
  v_and_b32 v195, 0xffff0000, v29
  v_lshlrev_b32 v196, 16, v30
  v_and_b32 v197, 0xffff0000, v30
  v_lshlrev_b32 v198, 16, v31
  v_and_b32 v199, 0xffff0000, v31
  v_lshlrev_b32 v232, 16, v32
  v_and_b32 v233, 0xffff0000, v32
  v_lshlrev_b32 v234, 16, v33
  v_and_b32 v235, 0xffff0000, v33
  v_lshlrev_b32 v236, 16, v34
  v_and_b32 v237, 0xffff0000, v34
  v_lshlrev_b32 v238, 16, v35
  v_and_b32 v239, 0xffff0000, v35
  v_lshlrev_b32 v200, 16, v32
  v_and_b32 v201, 0xffff0000, v32
  v_lshlrev_b32 v202, 16, v33
  v_and_b32 v203, 0xffff0000, v33
  v_lshlrev_b32 v204, 16, v34
  v_and_b32 v205, 0xffff0000, v34
  v_lshlrev_b32 v206, 16, v35
  v_and_b32 v207, 0xffff0000, v35
  v_lshlrev_b32 v240, 16, v36
  v_and_b32 v241, 0xffff0000, v36
  v_lshlrev_b32 v242, 16, v37
  v_and_b32 v243, 0xffff0000, v37
  v_lshlrev_b32 v244, 16, v38
  v_and_b32 v245, 0xffff0000, v38
  v_lshlrev_b32 v246, 16, v39
  v_and_b32 v247, 0xffff0000, v39
  v_lshlrev_b32 v208, 16, v36
  v_and_b32 v209, 0xffff0000, v36
  v_lshlrev_b32 v210, 16, v37
  v_and_b32 v211, 0xffff0000, v37
  v_lshlrev_b32 v212, 16, v38
  v_and_b32 v213, 0xffff0000, v38
  v_lshlrev_b32 v214, 16, v39
  v_and_b32 v215, 0xffff0000, v39
  v_mov_b32 v160, 0
  v_mov_b32 v161, 0
  v_mov_b32 v162, 0
  v_mov_b32 v163, 0
  v_mov_b32 v164, 0
  v_mov_b32 v165, 0
  v_mov_b32 v166, 0
  v_mov_b32 v167, 0
  v_mov_b32 v168, 0
  v_mov_b32 v169, 0
  v_mov_b32 v170, 0
  v_mov_b32 v171, 0
  v_mov_b32 v172, 0
  v_mov_b32 v173, 0
  v_mov_b32 v174, 0
  v_mov_b32 v175, 0
  v_mov_b32 v176, 0
  v_mov_b32 v177, 0
  v_mov_b32 v178, 0
  v_mov_b32 v179, 0
  v_mov_b32 v180, 0
  v_mov_b32 v181, 0
  v_mov_b32 v182, 0
  v_mov_b32 v183, 0
  s_add_u32 m0, s63, 0
  s_nop 0
  buffer_load_dwordx4 v6, s[12:15], s65 offen offset:0  lds
  s_add_u32 m0, s63, 32
  s_nop 0
  buffer_load_dwordx4 v6, s[12:15], s65 offen offset:1024  lds
  s_add_u32 m0, s63, 64
  s_nop 0
  buffer_load_dwordx4 v6, s[12:15], s65 offen offset:2048  lds
  s_add_u32 m0, s63, 96
  s_nop 0
  buffer_load_dwordx4 v6, s[12:15], s65 offen offset:3072  lds
  s_add_u32 m0, s48, 0
  s_nop 0
  buffer_load_dwordx4 v6, s[12:15], s66 offen offset:0  lds
  s_add_u32 m0, s48, 32
  s_nop 0
  buffer_load_dwordx4 v6, s[12:15], s66 offen offset:1024  lds
  s_add_u32 m0, s48, 64
  s_nop 0
  buffer_load_dwordx4 v6, s[12:15], s66 offen offset:2048  lds
  s_add_u32 m0, s48, 96
  s_nop 0
  buffer_load_dwordx4 v6, s[12:15], s66 offen offset:3072  lds
  s_cmp_eq_u32 s52, 3
  s_cbranch_scc0 L_si_bar
  buffer_wbl2 sc1
  s_waitcnt vmcnt(0)
  s_mov_b64 exec, 1
  s_or_b32 s72, s55, 0x60
  s_or_b32 s75, s75, 0x40404040
  v_mov_b32 v15, s72
L_poll2:
  buffer_store_byte v15, v14, s[28:31], s53 offen sc0 sc1
  s_waitcnt vmcnt(0)
  buffer_load_dword v2, v14, s[28:31], 0 offen sc0 sc1
  s_add_u32 s71, s71, 1
  s_waitcnt vmcnt(0)
  v_readfirstlane_b32 s73, v2
  s_cmp_gt_u32 s71, 0x8000
  s_cbranch_scc1 L_polled2
  s_and_b32 s72, s73, 0x5f5f5f5f
  s_mov_b32 s70, 0
  s_cmp_eq_u32 s72, s75
  s_cbranch_scc1 L_polled2
  s_mov_b32 s70, 1
  s_and_b32 s72, s73, 0x20202020
  s_cmp_eq_u32 s72, 0x20202020
  s_cbranch_scc0 L_poll2
L_polled2:
  v_mov_b32 v15, s70
  v_mov_b32 v2, 156164
  ds_write_b32 v2, v15
  s_mov_b64 exec, -1
  s_mov_b32 s71, 0
  s_waitcnt lgkmcnt(0)
L_si_bar:
  s_waitcnt vmcnt(0)
  s_barrier
  v_mov_b32 v2, 156164
  ds_read_b32 v2, v2
  s_waitcnt lgkmcnt(0)
  v_readfirstlane_b32 s70, v2
  s_nop 0
  s_cmp_lg_u32 s70, 0
  s_cbranch_scc0 L_topf
L_tops:
  s_waitcnt lgkmcnt(15)
  v_mfma_f32_16x16x32_bf16 v[120:123], a[0:3], v[24:27], 0
  v_fma_f32 v192, v224, v160, v192
  v_fma_f32 v193, v225, v161, v193
  v_fma_f32 v194, v226, v162, v194
  v_fma_f32 v195, v227, v163, v195
  v_mfma_f32_16x16x32_bf16 v[124:127], a[16:19], v[24:27], 0
  v_cvt_pk_bf16_f32 v28, v192, v193
  v_fma_f32 v196, v228, v164, v196
  v_fma_f32 v197, v229, v165, v197
  v_cvt_pk_bf16_f32 v29, v194, v195
  v_fma_f32 v198, v230, v166, v198
  v_fma_f32 v199, v231, v167, v199
  v_cvt_pk_bf16_f32 v30, v196, v197
  v_cvt_pk_bf16_f32 v31, v198, v199
  v_fma_f32 v200, v232, v168, v200
  v_fma_f32 v201, v233, v169, v201
  v_mfma_f32_16x16x32_bf16 v[120:123], a[4:7], v[28:31], v[120:123]
  v_fma_f32 v202, v234, v170, v202
  v_fma_f32 v203, v235, v171, v203
  v_cvt_pk_bf16_f32 v32, v200, v201
  v_fma_f32 v204, v236, v172, v204
  v_mfma_f32_16x16x32_bf16 v[124:127], a[20:23], v[28:31], v[124:127]
  v_fma_f32 v205, v237, v173, v205
  v_cvt_pk_bf16_f32 v33, v202, v203
  v_fma_f32 v206, v238, v174, v206
  v_fma_f32 v207, v239, v175, v207
  v_cvt_pk_bf16_f32 v34, v204, v205
  v_cvt_pk_bf16_f32 v35, v206, v207
  v_fma_f32 v208, v240, v176, v208
  v_fma_f32 v209, v241, v177, v209
  v_mfma_f32_16x16x32_bf16 v[120:123], a[8:11], v[32:35], v[120:123]
  v_fma_f32 v210, v242, v178, v210
  v_fma_f32 v211, v243, v179, v211
  v_cvt_pk_bf16_f32 v36, v208, v209
  v_fma_f32 v212, v244, v180, v212
  v_mfma_f32_16x16x32_bf16 v[124:127], a[24:27], v[32:35], v[124:127]
  v_fma_f32 v213, v245, v181, v213
  v_cvt_pk_bf16_f32 v37, v210, v211
  v_fma_f32 v214, v246, v182, v214
  v_fma_f32 v215, v247, v183, v215
  v_cvt_pk_bf16_f32 v38, v212, v213
  v_cvt_pk_bf16_f32 v39, v214, v215
  v_mfma_f32_16x16x32_bf16 v[128:131], a[32:35], v[24:27], 0
  ds_read_b128 v[152:155], v5 offset:0
  s_add_u32 m0, s48, 32
  v_mfma_f32_16x16x32_bf16 v[132:135], a[48:51], v[24:27], 0
  ds_read_b128 v[156:159], v5 offset:16
  buffer_load_dwordx4 v6, s[12:15], s66 offen offset:1024  lds
  v_mfma_f32_16x16x32_bf16 v[120:123], a[12:15], v[36:39], v[120:123]
  ds_read_b128 v[160:163], v5 offset:128
  s_add_u32 m0, s48, 64
  v_mfma_f32_16x16x32_bf16 v[124:127], a[28:31], v[36:39], v[124:127]
  ds_read_b128 v[164:167], v5 offset:144
  buffer_load_dwordx4 v6, s[12:15], s66 offen offset:2048  lds
  s_add_u32 m0, s48, 96
  v_mfma_f32_16x16x32_bf16 v[128:131], a[36:39], v[28:31], v[128:131]
  ds_read_b128 v[168:171], v5 offset:256
  buffer_load_dwordx4 v6, s[12:15], s66 offen offset:3072  lds
  v_mfma_f32_16x16x32_bf16 v[132:135], a[52:55], v[28:31], v[132:135]
  ds_read_b128 v[172:175], v5 offset:272
  v_cvt_pk_bf16_f32 v40, v120, v121
  v_cvt_pk_bf16_f32 v41, v122, v123
  v_mfma_f32_16x16x32_bf16 v[128:131], a[40:43], v[32:35], v[128:131]
  v_bfi_b32 v40, 1, s61, v40
  v_cvt_pk_bf16_f32 v42, v124, v125
  v_cvt_pk_bf16_f32 v43, v126, v127
  buffer_store_dwordx4 v[40:43], v8, s[32:35], s56 offen offset:0 sc1
  v_mfma_f32_16x16x32_bf16 v[132:135], a[56:59], v[32:35], v[132:135]
  ds_read_b128 v[176:179], v5 offset:384
  s_add_u32 s65, s65, 131072
  v_mfma_f32_16x16x32_bf16 v[128:131], a[44:47], v[36:39], v[128:131]
  ds_read_b128 v[180:183], v5 offset:400
  s_add_u32 s66, s66, 131072
  v_mfma_f32_16x16x32_bf16 v[132:135], a[60:63], v[36:39], v[132:135]
  s_add_u32 s67, s67, 131072
  s_waitcnt lgkmcnt(8)
  v_mfma_f32_16x16x32_bf16 v[136:139], a[64:67], v[24:27], 0
  s_add_u32 s50, s50, 131072
  s_xor_b32 s63, s63, s62
  v_mfma_f32_16x16x32_bf16 v[140:143], a[80:83], v[24:27], 0
  s_xor_b32 s48, s48, s49
  v_add_u32 v5, 512, v5
  v_mfma_f32_16x16x32_bf16 v[136:139], a[68:71], v[28:31], v[136:139]
  v_cvt_pk_bf16_f32 v44, v128, v129
  v_cvt_pk_bf16_f32 v45, v130, v131
  v_mfma_f32_16x16x32_bf16 v[140:143], a[84:87], v[28:31], v[140:143]
  v_bfi_b32 v44, 1, s61, v44
  v_cvt_pk_bf16_f32 v46, v132, v133
  v_mfma_f32_16x16x32_bf16 v[136:139], a[72:75], v[32:35], v[136:139]
  v_cvt_pk_bf16_f32 v47, v134, v135
  buffer_store_dwordx4 v[44:47], v8, s[32:35], s56 offen offset:1024 sc1
  v_mfma_f32_16x16x32_bf16 v[140:143], a[88:91], v[32:35], v[140:143]
  v_xor_b32 v4, v9, v4
  v_lshlrev_b32 v184, 16, v24
  v_mfma_f32_16x16x32_bf16 v[136:139], a[76:79], v[36:39], v[136:139]
  v_and_b32 v185, 0xffff0000, v24
  v_lshlrev_b32 v186, 16, v25
  v_mfma_f32_16x16x32_bf16 v[140:143], a[92:95], v[36:39], v[140:143]
  v_and_b32 v187, 0xffff0000, v25
  s_nop 0
  v_mfma_f32_16x16x32_bf16 v[144:147], a[96:99], v[24:27], 0
  s_nop 0
  s_nop 0
  v_mfma_f32_16x16x32_bf16 v[148:151], a[112:115], v[24:27], 0
  s_nop 0
  s_nop 0
  v_mfma_f32_16x16x32_bf16 v[144:147], a[100:103], v[28:31], v[144:147]
  v_cvt_pk_bf16_f32 v48, v136, v137
  v_cvt_pk_bf16_f32 v49, v138, v139
  v_mfma_f32_16x16x32_bf16 v[148:151], a[116:119], v[28:31], v[148:151]
  v_bfi_b32 v48, 1, s61, v48
  v_cvt_pk_bf16_f32 v50, v140, v141
  v_mfma_f32_16x16x32_bf16 v[144:147], a[104:107], v[32:35], v[144:147]
  v_cvt_pk_bf16_f32 v51, v142, v143
  buffer_store_dwordx4 v[48:51], v8, s[32:35], s56 offen offset:2048 sc1
  v_mfma_f32_16x16x32_bf16 v[148:151], a[120:123], v[32:35], v[148:151]
  v_mfma_f32_16x16x32_bf16 v[144:147], a[108:111], v[36:39], v[144:147]
  v_mfma_f32_16x16x32_bf16 v[148:151], a[124:127], v[36:39], v[148:151]
  v_lshlrev_b32 v188, 16, v26
  v_and_b32 v189, 0xffff0000, v26
  v_lshlrev_b32 v190, 16, v27
  v_and_b32 v191, 0xffff0000, v27
  v_lshlrev_b32 v192, 16, v28
  v_and_b32 v193, 0xffff0000, v28
  v_lshlrev_b32 v194, 16, v29
  v_and_b32 v195, 0xffff0000, v29
  v_cvt_pk_bf16_f32 v52, v144, v145
  v_cvt_pk_bf16_f32 v53, v146, v147
  v_bfi_b32 v52, 1, s61, v52
  v_cvt_pk_bf16_f32 v54, v148, v149
  v_cvt_pk_bf16_f32 v55, v150, v151
  buffer_store_dwordx4 v[52:55], v8, s[32:35], s56 offen offset:3072 sc1
L_Bs:
  s_waitcnt vmcnt(4)
  s_barrier
L_B2s:
  buffer_load_dwordx4 v[72:75], v8, s[32:35], s57 offen offset:0 sc1
  buffer_load_dwordx4 v[76:79], v8, s[32:35], s58 offen offset:0 sc1
  buffer_load_dwordx4 v[80:83], v8, s[32:35], s59 offen offset:0 sc1
  ds_read_b128 a[128:131], v4 offset:33792
  v_lshlrev_b32 v196, 16, v30
  ds_read_b128 a[144:147], v4 offset:34048
  v_and_b32 v197, 0xffff0000, v30
  ds_read_b128 a[160:163], v4 offset:42240
  v_lshlrev_b32 v198, 16, v31
  ds_read_b128 a[176:179], v4 offset:42496
  v_and_b32 v199, 0xffff0000, v31
  ds_read_b128 a[192:195], v4 offset:50688
  v_lshlrev_b32 v200, 16, v32
  buffer_load_dwordx4 v[84:87], v8, s[32:35], s57 offen offset:1024 sc1
  buffer_load_dwordx4 v[88:91], v8, s[32:35], s58 offen offset:1024 sc1
  buffer_load_dwordx4 v[92:95], v8, s[32:35], s59 offen offset:1024 sc1
  ds_read_b128 a[208:211], v4 offset:50944
  v_and_b32 v201, 0xffff0000, v32
  ds_read_b128 a[224:227], v4 offset:59136
  v_lshlrev_b32 v202, 16, v33
  ds_read_b128 a[240:243], v4 offset:59392
  v_and_b32 v203, 0xffff0000, v33
  ds_read_b128 a[132:135], v4 offset:33856
  v_lshlrev_b32 v204, 16, v34
  ds_read_b128 a[148:151], v4 offset:34112
  v_and_b32 v205, 0xffff0000, v34
  ds_read_b128 a[164:167], v4 offset:42304
  v_lshlrev_b32 v206, 16, v35
  ds_read_b128 a[180:183], v4 offset:42560
  v_and_b32 v207, 0xffff0000, v35
  buffer_load_dwordx4 v[96:99], v8, s[32:35], s57 offen offset:2048 sc1
  buffer_load_dwordx4 v[100:103], v8, s[32:35], s58 offen offset:2048 sc1
  buffer_load_dwordx4 v[104:107], v8, s[32:35], s59 offen offset:2048 sc1
  ds_read_b128 a[196:199], v4 offset:50752
  v_lshlrev_b32 v208, 16, v36
  ds_read_b128 a[212:215], v4 offset:51008
  v_and_b32 v209, 0xffff0000, v36
  ds_read_b128 a[228:231], v4 offset:59200
  v_lshlrev_b32 v210, 16, v37
  ds_read_b128 a[244:247], v4 offset:59456
  v_and_b32 v211, 0xffff0000, v37
  ds_read_b128 a[136:139], v4 offset:33920
  v_lshlrev_b32 v212, 16, v38
  ds_read_b128 a[152:155], v4 offset:34176
  v_and_b32 v213, 0xffff0000, v38
  ds_read_b128 a[168:171], v4 offset:42368
  v_lshlrev_b32 v214, 16, v39
  buffer_load_dwordx4 v[108:111], v8, s[32:35], s57 offen offset:3072 sc1
  buffer_load_dwordx4 v[112:115], v8, s[32:35], s58 offen offset:3072 sc1
  buffer_load_dwordx4 v[116:119], v8, s[32:35], s59 offen offset:3072 sc1
  ds_read_b128 a[184:187], v4 offset:42624
  v_and_b32 v215, 0xffff0000, v39
L_Cs:
  s_waitcnt vmcnt(9)
  v_mfma_f32_16x16x16_bf16 v[56:59], v[16:17], v[72:73], v[120:123]
  v_bitop3_b32 v10, v72, v76, s61 bitop3:0x7e
  v_bitop3_b32 v10, v10, v80, s61 bitop3:0xf6
  v_mfma_f32_16x16x16_bf16 v[60:63], v[16:17], v[74:75], v[124:127]
  v_and_b32 v10, 1, v10
  v_cmp_ne_u32 vcc, 0, v10
  v_mfma_f32_16x16x16_bf16 v[56:59], v[16:17], v[76:77], v[56:59]
  ds_read_b128 a[200:203], v4 offset:50816
  v_mfma_f32_16x16x16_bf16 v[60:63], v[16:17], v[78:79], v[60:63]
  ds_read_b128 a[216:219], v4 offset:51072
  v_mfma_f32_16x16x16_bf16 v[56:59], v[16:17], v[80:81], v[56:59]
  ds_read_b128 a[232:235], v4 offset:59264
  v_mfma_f32_16x16x16_bf16 v[60:63], v[16:17], v[82:83], v[60:63]
  s_cbranch_vccnz L_rt0s
L_go0s:
  s_waitcnt vmcnt(6)
  v_mfma_f32_16x16x16_bf16 v[64:67], v[16:17], v[84:85], v[128:131]
  v_bitop3_b32 v10, v84, v88, s61 bitop3:0x7e
  v_bitop3_b32 v10, v10, v92, s61 bitop3:0xf6
  v_mfma_f32_16x16x16_bf16 v[68:71], v[16:17], v[86:87], v[132:135]
  v_and_b32 v10, 1, v10
  v_cmp_ne_u32 vcc, 0, v10
  v_mfma_f32_16x16x16_bf16 v[64:67], v[16:17], v[88:89], v[64:67]
  v_cvt_pk_bf16_f32 v40, v56, v57
  v_cvt_pk_bf16_f32 v41, v58, v59
  v_mfma_f32_16x16x16_bf16 v[68:71], v[16:17], v[90:91], v[68:71]
  v_cvt_pk_bf16_f32 v42, v60, v61
  v_cvt_pk_bf16_f32 v43, v62, v63
  v_mfma_f32_16x16x16_bf16 v[64:67], v[16:17], v[92:93], v[64:67]
  ds_read_b128 a[248:251], v4 offset:59520
  s_add_u32 m0, s63, 33792
  v_mfma_f32_16x16x16_bf16 v[68:71], v[16:17], v[94:95], v[68:71]
  ds_read_b128 a[140:143], v4 offset:33984
  s_cbranch_vccnz L_rt1s
L_go1s:
  s_waitcnt lgkmcnt(15)
  v_mfma_f32_16x16x32_bf16 v[152:155], a[128:131], v[40:43], v[152:155]
  ds_read_b128 a[156:159], v4 offset:34240
  buffer_load_dwordx4 v7, s[8:11], s67 offen offset:0  lds
  v_mfma_f32_16x16x32_bf16 v[156:159], a[144:147], v[40:43], v[156:159]
  ds_read_b128 a[172:175], v4 offset:42432
  s_add_u32 m0, s63, 34592
  v_mfma_f32_16x16x32_bf16 v[160:163], a[160:163], v[40:43], v[160:163]
  ds_read_b128 a[188:191], v4 offset:42688
  buffer_load_dwordx4 v7, s[8:11], s67 offen offset:256  lds
  v_mfma_f32_16x16x32_bf16 v[164:167], a[176:179], v[40:43], v[164:167]
  ds_read_b128 a[204:207], v4 offset:50880
  v_cvt_pk_bf16_f32 v44, v64, v65
  v_cvt_pk_bf16_f32 v45, v66, v67
  v_mfma_f32_16x16x32_bf16 v[168:171], a[192:195], v[40:43], v[168:171]
  ds_read_b128 a[220:223], v4 offset:51136
  v_cvt_pk_bf16_f32 v46, v68, v69
  v_cvt_pk_bf16_f32 v47, v70, v71
  v_mfma_f32_16x16x32_bf16 v[172:175], a[208:211], v[40:43], v[172:175]
  ds_read_b128 a[236:239], v4 offset:59328
  s_add_u32 m0, s63, 35392
  v_mfma_f32_16x16x32_bf16 v[176:179], a[224:227], v[40:43], v[176:179]
  ds_read_b128 a[252:255], v4 offset:59584
  buffer_load_dwordx4 v7, s[8:11], s67 offen offset:512  lds
  v_mfma_f32_16x16x32_bf16 v[180:183], a[240:243], v[40:43], v[180:183]
  ds_read_b128 a[0:3], v4 offset:0
  s_add_u32 m0, s63, 36192
  s_waitcnt vmcnt(6)
  v_mfma_f32_16x16x16_bf16 v[56:59], v[16:17], v[96:97], v[136:139]
  ds_read_b128 a[16:19], v4 offset:256
  v_bitop3_b32 v10, v96, v100, s61 bitop3:0x7e
  v_bitop3_b32 v10, v10, v104, s61 bitop3:0xf6
  v_mfma_f32_16x16x16_bf16 v[60:63], v[16:17], v[98:99], v[140:143]
  ds_read_b128 a[4:7], v4 offset:64
  v_and_b32 v10, 1, v10
  v_cmp_ne_u32 vcc, 0, v10
  v_mfma_f32_16x16x16_bf16 v[56:59], v[16:17], v[100:101], v[56:59]
  ds_read_b128 a[20:23], v4 offset:320
  buffer_load_dwordx4 v7, s[8:11], s67 offen offset:768  lds
  v_mfma_f32_16x16x16_bf16 v[60:63], v[16:17], v[102:103], v[60:63]
  ds_read_b128 a[8:11], v4 offset:128
  s_add_u32 m0, s48, 33792
  v_mfma_f32_16x16x16_bf16 v[56:59], v[16:17], v[104:105], v[56:59]
  ds_read_b128 a[24:27], v4 offset:384
  buffer_load_dwordx4 v7, s[8:11], s50 offen offset:0  lds
  v_mfma_f32_16x16x16_bf16 v[60:63], v[16:17], v[106:107], v[60:63]
  ds_read_b128 a[12:15], v4 offset:192
  s_cbranch_vccnz L_rt2s
L_go2s:
  s_waitcnt lgkmcnt(15)
  v_mfma_f32_16x16x32_bf16 v[152:155], a[132:135], v[44:47], v[152:155]
  ds_read_b128 a[28:31], v4 offset:448
  s_add_u32 m0, s48, 34592
  v_mfma_f32_16x16x32_bf16 v[156:159], a[148:151], v[44:47], v[156:159]
  ds_read_b128 a[32:35], v4 offset:8448
  buffer_load_dwordx4 v7, s[8:11], s50 offen offset:256  lds
  v_mfma_f32_16x16x32_bf16 v[160:163], a[164:167], v[44:47], v[160:163]
  ds_read_b128 a[48:51], v4 offset:8704
  s_add_u32 m0, s48, 35392
  v_mfma_f32_16x16x32_bf16 v[164:167], a[180:183], v[44:47], v[164:167]
  ds_read_b128 a[36:39], v4 offset:8512
  v_cvt_pk_bf16_f32 v48, v56, v57
  v_cvt_pk_bf16_f32 v49, v58, v59
  v_mfma_f32_16x16x32_bf16 v[168:171], a[196:199], v[44:47], v[168:171]
  ds_read_b128 a[52:55], v4 offset:8768
  v_cvt_pk_bf16_f32 v50, v60, v61
  v_cvt_pk_bf16_f32 v51, v62, v63
  v_mfma_f32_16x16x32_bf16 v[172:175], a[212:215], v[44:47], v[172:175]
  ds_read_b128 a[40:43], v4 offset:8576
  buffer_load_dwordx4 v7, s[8:11], s50 offen offset:512  lds
  s_add_u32 m0, s48, 36192
  v_mfma_f32_16x16x32_bf16 v[176:179], a[228:231], v[44:47], v[176:179]
  ds_read_b128 a[56:59], v4 offset:8832
  buffer_load_dwordx4 v7, s[8:11], s50 offen offset:768  lds
  v_mfma_f32_16x16x32_bf16 v[180:183], a[244:247], v[44:47], v[180:183]
  ds_read_b128 a[44:47], v4 offset:8640
  s_waitcnt lgkmcnt(15)
  v_mfma_f32_16x16x32_bf16 v[152:155], a[136:139], v[48:51], v[152:155]
  ds_read_b128 a[60:63], v4 offset:8896
  s_add_u32 m0, s63, 0
  v_mfma_f32_16x16x32_bf16 v[156:159], a[152:155], v[48:51], v[156:159]
  ds_read_b128 a[64:67], v4 offset:16896
  buffer_load_dwordx4 v6, s[12:15], s65 offen offset:0  lds
  v_mfma_f32_16x16x32_bf16 v[160:163], a[168:171], v[48:51], v[160:163]
  ds_read_b128 a[80:83], v4 offset:17152
  v_mfma_f32_16x16x32_bf16 v[164:167], a[184:187], v[48:51], v[164:167]
  ds_read_b128 a[68:71], v4 offset:16960
  s_waitcnt vmcnt(9)
  v_mfma_f32_16x16x16_bf16 v[64:67], v[16:17], v[108:109], v[144:147]
  ds_read_b128 a[84:87], v4 offset:17216
  v_bitop3_b32 v10, v108, v112, s61 bitop3:0x7e
  v_bitop3_b32 v10, v10, v116, s61 bitop3:0xf6
  v_mfma_f32_16x16x16_bf16 v[68:71], v[16:17], v[110:111], v[148:151]
  ds_read_b128 a[72:75], v4 offset:17024
  v_and_b32 v10, 1, v10
  v_cmp_ne_u32 vcc, 0, v10
  v_mfma_f32_16x16x16_bf16 v[64:67], v[16:17], v[112:113], v[64:67]
  ds_read_b128 a[88:91], v4 offset:17280
  s_add_u32 m0, s63, 32
  v_mfma_f32_16x16x16_bf16 v[68:71], v[16:17], v[114:115], v[68:71]
  ds_read_b128 a[76:79], v4 offset:17088
  buffer_load_dwordx4 v6, s[12:15], s65 offen offset:1024  lds
  v_mfma_f32_16x16x16_bf16 v[64:67], v[16:17], v[116:117], v[64:67]
  ds_read_b128 a[92:95], v4 offset:17344
  s_add_u32 m0, s63, 64
  v_mfma_f32_16x16x16_bf16 v[68:71], v[16:17], v[118:119], v[68:71]
  ds_read_b128 a[96:99], v4 offset:25344
  s_cbranch_vccnz L_rt3s
L_go3s:
  v_mfma_f32_16x16x32_bf16 v[168:171], a[200:203], v[48:51], v[168:171]
  ds_read_b128 a[112:115], v4 offset:25600
  s_add_u32 s60, s60, 1
  s_lshr_b32 s61, s60, 1
  v_mfma_f32_16x16x32_bf16 v[172:175], a[216:219], v[48:51], v[172:175]
  ds_read_b128 a[100:103], v4 offset:25408
  s_andn2_b32 s61, 1, s61
  v_mfma_f32_16x16x32_bf16 v[176:179], a[232:235], v[48:51], v[176:179]
  ds_read_b128 a[116:119], v4 offset:25664
  v_cvt_pk_bf16_f32 v52, v64, v65
  v_cvt_pk_bf16_f32 v53, v66, v67
  v_mfma_f32_16x16x32_bf16 v[180:183], a[248:251], v[48:51], v[180:183]
  v_cvt_pk_bf16_f32 v54, v68, v69
  v_cvt_pk_bf16_f32 v55, v70, v71
  s_bitcmp1_b32 s60, 0
  s_cselect_b64 s[32:33], s[24:25], s[20:21]
  s_waitcnt lgkmcnt(15)
  v_mfma_f32_16x16x32_bf16 v[152:155], a[140:143], v[52:55], v[152:155]
  ds_read_b128 a[104:107], v4 offset:25472
  buffer_load_dwordx4 v6, s[12:15], s65 offen offset:2048  lds
  s_add_u32 m0, s63, 96
  v_mfma_f32_16x16x32_bf16 v[156:159], a[156:159], v[52:55], v[156:159]
  ds_read_b128 a[120:123], v4 offset:25728
  buffer_load_dwordx4 v6, s[12:15], s65 offen offset:3072  lds
  v_mfma_f32_16x16x32_bf16 v[160:163], a[172:175], v[52:55], v[160:163]
  ds_read_b128 a[108:111], v4 offset:25536
  s_add_u32 m0, s48, 0
  v_mfma_f32_16x16x32_bf16 v[164:167], a[188:191], v[52:55], v[164:167]
  ds_read_b128 a[124:127], v4 offset:25792
  buffer_load_dwordx4 v6, s[12:15], s66 offen offset:0  lds
  v_mfma_f32_16x16x32_bf16 v[168:171], a[204:207], v[52:55], v[168:171]
  v_fma_f32 v184, v216, v152, v184
  v_fma_f32 v185, v217, v153, v185
  v_mfma_f32_16x16x32_bf16 v[172:175], a[220:223], v[52:55], v[172:175]
  v_fma_f32 v186, v218, v154, v186
  v_fma_f32 v187, v219, v155, v187
  v_mfma_f32_16x16x32_bf16 v[176:179], a[236:239], v[52:55], v[176:179]
  v_cvt_pk_bf16_f32 v24, v184, v185
  v_fma_f32 v188, v220, v156, v188
  v_mfma_f32_16x16x32_bf16 v[180:183], a[252:255], v[52:55], v[180:183]
  v_fma_f32 v189, v221, v157, v189
  v_cvt_pk_bf16_f32 v25, v186, v187
  v_fma_f32 v190, v222, v158, v190
  v_fma_f32 v191, v223, v159, v191
  v_cvt_pk_bf16_f32 v26, v188, v189
  v_cvt_pk_bf16_f32 v27, v190, v191
  s_cmp_lt_u32 s60, 6
  s_cbranch_scc1 L_tops
  s_branch L_epi
L_rt0s:
L_rf0s:
  buffer_load_dwordx4 v[72:75], v8, s[32:35], s57 offen offset:0 sc1
  buffer_load_dwordx4 v[76:79], v8, s[32:35], s58 offen offset:0 sc1
  buffer_load_dwordx4 v[80:83], v8, s[32:35], s59 offen offset:0 sc1
  buffer_load_dwordx4 v[84:87], v8, s[32:35], s57 offen offset:1024 sc1
  buffer_load_dwordx4 v[88:91], v8, s[32:35], s58 offen offset:1024 sc1
  buffer_load_dwordx4 v[92:95], v8, s[32:35], s59 offen offset:1024 sc1
  buffer_load_dwordx4 v[96:99], v8, s[32:35], s57 offen offset:2048 sc1
  buffer_load_dwordx4 v[100:103], v8, s[32:35], s58 offen offset:2048 sc1
  buffer_load_dwordx4 v[104:107], v8, s[32:35], s59 offen offset:2048 sc1
  buffer_load_dwordx4 v[108:111], v8, s[32:35], s57 offen offset:3072 sc1
  buffer_load_dwordx4 v[112:115], v8, s[32:35], s58 offen offset:3072 sc1
  buffer_load_dwordx4 v[116:119], v8, s[32:35], s59 offen offset:3072 sc1
  s_waitcnt vmcnt(9)
  v_bitop3_b32 v10, v72, v76, s61 bitop3:0x7e
  v_bitop3_b32 v10, v10, v80, s61 bitop3:0xf6
  v_and_b32 v10, 1, v10
  v_cmp_ne_u32 vcc, 0, v10
  s_cbranch_vccnz L_pl0s
L_rs0s:
  v_mfma_f32_16x16x16_bf16 v[56:59], v[16:17], v[72:73], v[120:123]
  v_mfma_f32_16x16x16_bf16 v[60:63], v[16:17], v[74:75], v[124:127]
  v_mfma_f32_16x16x16_bf16 v[56:59], v[16:17], v[76:77], v[56:59]
  v_mfma_f32_16x16x16_bf16 v[60:63], v[16:17], v[78:79], v[60:63]
  v_mfma_f32_16x16x16_bf16 v[56:59], v[16:17], v[80:81], v[56:59]
  v_mfma_f32_16x16x16_bf16 v[60:63], v[16:17], v[82:83], v[60:63]
  s_branch L_go0s
L_pl0s:
  s_mov_b64 exec, 1
L_pp0s:
  buffer_load_dword v72, v8, s[32:35], s57 offen offset:0 sc1
  buffer_load_dword v76, v8, s[32:35], s58 offen offset:0 sc1
  buffer_load_dword v80, v8, s[32:35], s59 offen offset:0 sc1
  s_add_u32 s71, s71, 1
  s_waitcnt vmcnt(0)
  v_bitop3_b32 v10, v72, v76, s61 bitop3:0x7e
  v_bitop3_b32 v10, v10, v80, s61 bitop3:0xf6
  v_and_b32 v10, 1, v10
  v_cmp_ne_u32 vcc, 0, v10
  s_cmp_gt_u32 s71, 0x40000
  s_cbranch_scc1 L_gu0s
  s_cbranch_vccnz L_pp0s
  s_mov_b64 exec, -1
  s_branch L_rf0s
L_gu0s:
  s_mov_b64 exec, -1
  s_branch L_rs0s
L_rt1s:
L_rf1s:
  buffer_load_dwordx4 v[84:87], v8, s[32:35], s57 offen offset:1024 sc1
  buffer_load_dwordx4 v[88:91], v8, s[32:35], s58 offen offset:1024 sc1
  buffer_load_dwordx4 v[92:95], v8, s[32:35], s59 offen offset:1024 sc1
  buffer_load_dwordx4 v[96:99], v8, s[32:35], s57 offen offset:2048 sc1
  buffer_load_dwordx4 v[100:103], v8, s[32:35], s58 offen offset:2048 sc1
  buffer_load_dwordx4 v[104:107], v8, s[32:35], s59 offen offset:2048 sc1
  buffer_load_dwordx4 v[108:111], v8, s[32:35], s57 offen offset:3072 sc1
  buffer_load_dwordx4 v[112:115], v8, s[32:35], s58 offen offset:3072 sc1
  buffer_load_dwordx4 v[116:119], v8, s[32:35], s59 offen offset:3072 sc1
  s_waitcnt vmcnt(6)
  v_bitop3_b32 v10, v84, v88, s61 bitop3:0x7e
  v_bitop3_b32 v10, v10, v92, s61 bitop3:0xf6
  v_and_b32 v10, 1, v10
  v_cmp_ne_u32 vcc, 0, v10
  s_cbranch_vccnz L_pl1s
L_rs1s:
  v_mfma_f32_16x16x16_bf16 v[64:67], v[16:17], v[84:85], v[128:131]
  v_mfma_f32_16x16x16_bf16 v[68:71], v[16:17], v[86:87], v[132:135]
  v_mfma_f32_16x16x16_bf16 v[64:67], v[16:17], v[88:89], v[64:67]
  v_mfma_f32_16x16x16_bf16 v[68:71], v[16:17], v[90:91], v[68:71]
  v_mfma_f32_16x16x16_bf16 v[64:67], v[16:17], v[92:93], v[64:67]
  v_mfma_f32_16x16x16_bf16 v[68:71], v[16:17], v[94:95], v[68:71]
  s_branch L_go1s
L_pl1s:
  s_mov_b64 exec, 1
L_pp1s:
  buffer_load_dword v84, v8, s[32:35], s57 offen offset:1024 sc1
  buffer_load_dword v88, v8, s[32:35], s58 offen offset:1024 sc1
  buffer_load_dword v92, v8, s[32:35], s59 offen offset:1024 sc1
  s_add_u32 s71, s71, 1
  s_waitcnt vmcnt(0)
  v_bitop3_b32 v10, v84, v88, s61 bitop3:0x7e
  v_bitop3_b32 v10, v10, v92, s61 bitop3:0xf6
  v_and_b32 v10, 1, v10
  v_cmp_ne_u32 vcc, 0, v10
  s_cmp_gt_u32 s71, 0x40000
  s_cbranch_scc1 L_gu1s
  s_cbranch_vccnz L_pp1s
  s_mov_b64 exec, -1
  s_branch L_rf1s
L_gu1s:
  s_mov_b64 exec, -1
  s_branch L_rs1s
L_rt2s:
L_rf2s:
  buffer_load_dwordx4 v[96:99], v8, s[32:35], s57 offen offset:2048 sc1
  buffer_load_dwordx4 v[100:103], v8, s[32:35], s58 offen offset:2048 sc1
  buffer_load_dwordx4 v[104:107], v8, s[32:35], s59 offen offset:2048 sc1
  buffer_load_dwordx4 v[108:111], v8, s[32:35], s57 offen offset:3072 sc1
  buffer_load_dwordx4 v[112:115], v8, s[32:35], s58 offen offset:3072 sc1
  buffer_load_dwordx4 v[116:119], v8, s[32:35], s59 offen offset:3072 sc1
  s_mov_b64 exec, 1
  buffer_load_dword v13, v8, s[32:35], s56 offen
  buffer_load_dword v13, v8, s[32:35], s56 offen
  buffer_load_dword v13, v8, s[32:35], s56 offen
  buffer_load_dword v13, v8, s[32:35], s56 offen
  buffer_load_dword v13, v8, s[32:35], s56 offen
  s_mov_b64 exec, -1
  s_waitcnt vmcnt(8)
  v_bitop3_b32 v10, v96, v100, s61 bitop3:0x7e
  v_bitop3_b32 v10, v10, v104, s61 bitop3:0xf6
  v_and_b32 v10, 1, v10
  v_cmp_ne_u32 vcc, 0, v10
  s_cbranch_vccnz L_pl2s
L_rs2s:
  v_mfma_f32_16x16x16_bf16 v[56:59], v[16:17], v[96:97], v[136:139]
  v_mfma_f32_16x16x16_bf16 v[60:63], v[16:17], v[98:99], v[140:143]
  v_mfma_f32_16x16x16_bf16 v[56:59], v[16:17], v[100:101], v[56:59]
  v_mfma_f32_16x16x16_bf16 v[60:63], v[16:17], v[102:103], v[60:63]
  v_mfma_f32_16x16x16_bf16 v[56:59], v[16:17], v[104:105], v[56:59]
  v_mfma_f32_16x16x16_bf16 v[60:63], v[16:17], v[106:107], v[60:63]
  s_branch L_go2s
L_pl2s:
  s_mov_b64 exec, 1
L_pp2s:
  buffer_load_dword v96, v8, s[32:35], s57 offen offset:2048 sc1
  buffer_load_dword v100, v8, s[32:35], s58 offen offset:2048 sc1
  buffer_load_dword v104, v8, s[32:35], s59 offen offset:2048 sc1
  s_add_u32 s71, s71, 1
  s_waitcnt vmcnt(0)
  v_bitop3_b32 v10, v96, v100, s61 bitop3:0x7e
  v_bitop3_b32 v10, v10, v104, s61 bitop3:0xf6
  v_and_b32 v10, 1, v10
  v_cmp_ne_u32 vcc, 0, v10
  s_cmp_gt_u32 s71, 0x40000
  s_cbranch_scc1 L_gu2s
  s_cbranch_vccnz L_pp2s
  s_mov_b64 exec, -1
  s_branch L_rf2s
L_gu2s:
  s_mov_b64 exec, -1
  s_branch L_rs2s
L_rt3s:
L_rf3s:
  buffer_load_dwordx4 v[108:111], v8, s[32:35], s57 offen offset:3072 sc1
  buffer_load_dwordx4 v[112:115], v8, s[32:35], s58 offen offset:3072 sc1
  buffer_load_dwordx4 v[116:119], v8, s[32:35], s59 offen offset:3072 sc1
  s_waitcnt vmcnt(0)
  v_bitop3_b32 v10, v108, v112, s61 bitop3:0x7e
  v_bitop3_b32 v10, v10, v116, s61 bitop3:0xf6
  v_and_b32 v10, 1, v10
  v_cmp_ne_u32 vcc, 0, v10
  s_cbranch_vccnz L_pl3s
L_rs3s:
  v_mfma_f32_16x16x16_bf16 v[64:67], v[16:17], v[108:109], v[144:147]
  v_mfma_f32_16x16x16_bf16 v[68:71], v[16:17], v[110:111], v[148:151]
  v_mfma_f32_16x16x16_bf16 v[64:67], v[16:17], v[112:113], v[64:67]
  v_mfma_f32_16x16x16_bf16 v[68:71], v[16:17], v[114:115], v[68:71]
  v_mfma_f32_16x16x16_bf16 v[64:67], v[16:17], v[116:117], v[64:67]
  v_mfma_f32_16x16x16_bf16 v[68:71], v[16:17], v[118:119], v[68:71]
  s_branch L_go3s
L_pl3s:
  s_mov_b64 exec, 1
L_pp3s:
  buffer_load_dword v108, v8, s[32:35], s57 offen offset:3072 sc1
  buffer_load_dword v112, v8, s[32:35], s58 offen offset:3072 sc1
  buffer_load_dword v116, v8, s[32:35], s59 offen offset:3072 sc1
  s_add_u32 s71, s71, 1
  s_waitcnt vmcnt(0)
  v_bitop3_b32 v10, v108, v112, s61 bitop3:0x7e
  v_bitop3_b32 v10, v10, v116, s61 bitop3:0xf6
  v_and_b32 v10, 1, v10
  v_cmp_ne_u32 vcc, 0, v10
  s_cmp_gt_u32 s71, 0x40000
  s_cbranch_scc1 L_gu3s
  s_cbranch_vccnz L_pp3s
  s_mov_b64 exec, -1
  s_branch L_rf3s
L_gu3s:
  s_mov_b64 exec, -1
  s_branch L_rs3s
.section .rodata,"a"
.p2align 6
.amdhsa_kernel standalone__cross_network_dcn_v2__recsys_kernel
  .amdhsa_next_free_vgpr 512
  .amdhsa_next_free_sgpr 102
  .amdhsa_accum_offset 256
  .amdhsa_group_segment_fixed_size 0
  .amdhsa_kernarg_size 56
  .amdhsa_user_sgpr_count 2
  .amdhsa_user_sgpr_kernarg_segment_ptr 1
  .amdhsa_system_sgpr_workgroup_id_x 1
.end_amdhsa_kernel
```
